```python
import torch

def _softmax(x, axis=-1):
    return torch.softmax(x, dim=axis)
def _gelu(x):
    return torch.nn.functional.gelu(x, approximate="tanh")
def _silu(x):
    return torch.nn.functional.silu(x)
def _sigmoid(x):
    return torch.sigmoid(x)
def _layernorm(x, axis=-1, eps=1e-5):
    m = x.mean(dim=axis, keepdim=True)
    v = x.var(dim=axis, keepdim=True, unbiased=False)
    return (x - m) / torch.sqrt(v + eps)
def _scatter_add(tgt, idx, src, axis=0):
    return tgt.clone().index_add_(axis, idx, src)
def _segment_sum(src, seg, n):
    out = torch.zeros((n,) + src.shape[1:], dtype=src.dtype)
    return out.index_add_(0, seg, src)
def _pad(x, pw):
    flat = tuple(v for pair in reversed(pw) for v in pair)
    return torch.nn.functional.pad(x, flat)

kernel_name = 'recurrent_scan__linear_attn_block__geglu_ffn__prompt'

def setup_inputs():

    _w = (lambda a: (lambda t: t.to(torch.bfloat16) if t.is_floating_point() else t)(torch.as_tensor(a)))
    def _A_setup():
        B, S, D = 1, 2048, 512
        return {
            "x": _w((lambda *s: torch.randn(*s, dtype=torch.bfloat16) * 0.05)(B, S, D)),
            "wqkv": _w((lambda *s: torch.randn(*s, dtype=torch.bfloat16) * 0.05)(D, 3 * D)),
            "wo": _w((lambda *s: torch.randn(*s, dtype=torch.bfloat16) * 0.05)(D, D)),
        }
    _A_in = _A_setup()

    def _B_setup():
        B, S, D, F = 1, 2048, 512, 1792
        return {
            "x": _w((lambda *s: torch.randn(*s, dtype=torch.bfloat16) * 0.05)(B, S, D)),
            "w_gate": _w((lambda *s: torch.randn(*s, dtype=torch.bfloat16) * 0.05)(D, F)),
            "w_up": _w((lambda *s: torch.randn(*s, dtype=torch.bfloat16) * 0.05)(D, F)),
            "w_down": _w((lambda *s: torch.randn(*s, dtype=torch.bfloat16) * 0.05)(F, D)),
        }
    _B_in = _B_setup()

    return {
        "A_x": _A_in["x"],
        "A_wqkv": _A_in["wqkv"],
        "A_wo": _A_in["wo"],
        "B_x": _B_in["x"],
        "B_w_gate": _B_in["w_gate"],
        "B_w_up": _B_in["w_up"],
        "B_w_down": _B_in["w_down"],
    }

def reference(A_x, A_wqkv, A_wo, B_x, B_w_gate, B_w_up, B_w_down):
    def _A_ref(x, wqkv, wo):
        B, S, D = x.shape
        H = 32; Dh = D // H
        qkv = (lambda x, *d: x.permute(*d))((x @ wqkv).reshape(B, S, 3, H, Dh), 2, 0, 3, 1, 4)
        q, k, v = qkv[0], qkv[1], qkv[2]
        phi = lambda t: torch.where(t > 0, t + 1, torch.exp(t)) + 1e-6
        pq, pk = phi(q), phi(k)
        kv = torch.einsum("bhsd,bhse->bhde", pk, v)
        z = torch.einsum("bhsd->bhd", pk)
        num = torch.einsum("bhqd,bhde->bhqe", pq, kv)
        den = torch.einsum("bhqd,bhd->bhq", pq, z)[..., None] + 1e-6
        o = num / den
        return (lambda x, *d: x.permute(*d))(o, 0, 2, 1, 3).reshape(B, S, D) @ wo

    def _B_ref(x, w_gate, w_up, w_down):
        return (_gelu(x @ w_gate) * (x @ w_up)) @ w_down

    x = A_x
    xn = _layernorm(x, axis=-1)
    s = _A_ref(xn, A_wqkv, A_wo)
    g = _silu(_B_ref(xn, B_w_gate, B_w_up, B_w_down))
    return x + s * g
```

```asm
; @launch kernel=recurrent_scan__linear_attn_block__geglu_ffn__prompt_kernel grid=(593,1,1) block=(256,1,1) lds=18432
; @launch kernel=k1_gemm_kernel grid=(256,1,1) block=(512,1,1) lds=98304
; @launch kernel=k2_gemm_kernel grid=(256,1,1) block=(256,1,1) lds=131072
.amdgcn_target "amdgcn-amd-amdhsa--gfx950"
.text
.globl recurrent_scan__linear_attn_block__geglu_ffn__prompt_kernel
.p2align 8
.type recurrent_scan__linear_attn_block__geglu_ffn__prompt_kernel,@function
recurrent_scan__linear_attn_block__geglu_ffn__prompt_kernel:
    s_cmp_ge_u32 s2, 593
    s_cbranch_scc1 K0_END
    s_load_dwordx8 s[8:15], s[0:1], 0
    s_load_dwordx8 s[16:23], s[0:1], 32
    s_load_dwordx4 s[24:27], s[0:1], 64
    s_waitcnt lgkmcnt(0)
    s_mov_b32 s28, s26
    s_and_b32 s29, s27, 0xffff
    s_mov_b32 s30, 0x1400000
    s_mov_b32 s31, 0x00020000
    s_mov_b32 s32, s8
    s_and_b32 s33, s9, 0xffff
    s_mov_b32 s34, 0x200000
    s_mov_b32 s35, 0x00020000
    s_mov_b32 s36, s10
    s_and_b32 s37, s11, 0xffff
    s_mov_b32 s38, 0x180000
    s_mov_b32 s39, 0x00020000
    s_mov_b32 s40, s12
    s_and_b32 s41, s13, 0xffff
    s_mov_b32 s42, 0x80000
    s_mov_b32 s43, 0x00020000
    s_mov_b32 s44, s16
    s_and_b32 s45, s17, 0xffff
    s_mov_b32 s46, 0x1c0000
    s_mov_b32 s47, 0x00020000
    s_mov_b32 s48, s18
    s_and_b32 s49, s19, 0xffff
    s_mov_b32 s50, 0x1c0000
    s_mov_b32 s51, 0x00020000
    s_mov_b32 s52, s20
    s_and_b32 s53, s21, 0xffff
    s_mov_b32 s54, 0x1c0000
    s_mov_b32 s55, 0x00020000
    s_cmp_lt_u32 s2, 128
    s_cbranch_scc1 K0_LNPATH
    s_cmp_lt_u32 s2, 224
    s_cbranch_scc1 K0_SHUF0
    s_cmp_lt_u32 s2, 336
    s_cbranch_scc1 K0_SHUF1
    s_cmp_lt_u32 s2, 448
    s_cbranch_scc1 K0_SHUF2
    s_cmp_lt_u32 s2, 560
    s_cbranch_scc1 K0_SHUF3
    s_cmp_lt_u32 s2, 592
    s_cbranch_scc1 K0_SHUF4
    v_mov_b32 v4, 0
    v_mov_b32 v5, 0
    v_mov_b32 v6, 0
    v_mov_b32 v7, 0
    v_lshlrev_b32 v1, 4, v0
    s_mov_b32 s60, 0x1300000
    buffer_store_dwordx4 v[4:7], v1, s[28:31], s60 offen sc1
    s_add_u32 s60, s60, 4096
    buffer_store_dwordx4 v[4:7], v1, s[28:31], s60 offen sc1
    s_add_u32 s60, s60, 4096
    buffer_store_dwordx4 v[4:7], v1, s[28:31], s60 offen sc1
    s_add_u32 s60, s60, 4096
    buffer_store_dwordx4 v[4:7], v1, s[28:31], s60 offen sc1
    s_add_u32 s60, s60, 4096
    buffer_store_dwordx4 v[4:7], v1, s[28:31], s60 offen sc1
    s_add_u32 s60, s60, 4096
    buffer_store_dwordx4 v[4:7], v1, s[28:31], s60 offen sc1
    s_add_u32 s60, s60, 4096
    buffer_store_dwordx4 v[4:7], v1, s[28:31], s60 offen sc1
    s_add_u32 s60, s60, 4096
    buffer_store_dwordx4 v[4:7], v1, s[28:31], s60 offen sc1
    s_add_u32 s60, s60, 4096
    buffer_store_dwordx4 v[4:7], v1, s[28:31], s60 offen sc1
    s_add_u32 s60, s60, 4096
    buffer_store_dwordx4 v[4:7], v1, s[28:31], s60 offen sc1
    s_add_u32 s60, s60, 4096
    buffer_store_dwordx4 v[4:7], v1, s[28:31], s60 offen sc1
    s_add_u32 s60, s60, 4096
    buffer_store_dwordx4 v[4:7], v1, s[28:31], s60 offen sc1
    s_add_u32 s60, s60, 4096
    buffer_store_dwordx4 v[4:7], v1, s[28:31], s60 offen sc1
    s_add_u32 s60, s60, 4096
    buffer_store_dwordx4 v[4:7], v1, s[28:31], s60 offen sc1
    s_add_u32 s60, s60, 4096
    buffer_store_dwordx4 v[4:7], v1, s[28:31], s60 offen sc1
    s_add_u32 s60, s60, 4096
    buffer_store_dwordx4 v[4:7], v1, s[28:31], s60 offen sc1
    s_branch K0_END
K0_LNPATH:
    s_lshl_b32 s60, s2, 14
    v_lshrrev_b32 v1, 4, v0
    v_and_b32 v2, 15, v0
    v_lshlrev_b32 v3, 10, v1
    v_lshl_add_u32 v3, v2, 4, v3
    buffer_load_dwordx4 v[4:7], v3, s[32:35], s60 offen offset:0
    buffer_load_dwordx4 v[8:11], v3, s[32:35], s60 offen offset:256
    buffer_load_dwordx4 v[12:15], v3, s[32:35], s60 offen offset:512
    buffer_load_dwordx4 v[16:19], v3, s[32:35], s60 offen offset:768
    s_waitcnt vmcnt(3)
    v_mov_b32 v60, v4
    s_waitcnt vmcnt(0)
    v_mov_b32 v60, v19
    v_lshlrev_b32 v20, 16, v4
    v_and_b32 v21, 0xffff0000, v4
    v_lshlrev_b32 v22, 16, v5
    v_and_b32 v23, 0xffff0000, v5
    v_lshlrev_b32 v24, 16, v6
    v_and_b32 v25, 0xffff0000, v6
    v_lshlrev_b32 v26, 16, v7
    v_and_b32 v27, 0xffff0000, v7
    v_lshlrev_b32 v28, 16, v8
    v_and_b32 v29, 0xffff0000, v8
    v_lshlrev_b32 v30, 16, v9
    v_and_b32 v31, 0xffff0000, v9
    v_lshlrev_b32 v32, 16, v10
    v_and_b32 v33, 0xffff0000, v10
    v_lshlrev_b32 v34, 16, v11
    v_and_b32 v35, 0xffff0000, v11
    v_lshlrev_b32 v36, 16, v12
    v_and_b32 v37, 0xffff0000, v12
    v_lshlrev_b32 v38, 16, v13
    v_and_b32 v39, 0xffff0000, v13
    v_lshlrev_b32 v40, 16, v14
    v_and_b32 v41, 0xffff0000, v14
    v_lshlrev_b32 v42, 16, v15
    v_and_b32 v43, 0xffff0000, v15
    v_lshlrev_b32 v44, 16, v16
    v_and_b32 v45, 0xffff0000, v16
    v_lshlrev_b32 v46, 16, v17
    v_and_b32 v47, 0xffff0000, v17
    v_lshlrev_b32 v48, 16, v18
    v_and_b32 v49, 0xffff0000, v18
    v_lshlrev_b32 v50, 16, v19
    v_and_b32 v51, 0xffff0000, v19
    v_add_f32 v52, v20, v21
    v_add_f32 v53, v22, v23
    v_add_f32 v52, v52, v24
    v_add_f32 v53, v53, v25
    v_add_f32 v52, v52, v26
    v_add_f32 v53, v53, v27
    v_add_f32 v52, v52, v28
    v_add_f32 v53, v53, v29
    v_add_f32 v52, v52, v30
    v_add_f32 v53, v53, v31
    v_add_f32 v52, v52, v32
    v_add_f32 v53, v53, v33
    v_add_f32 v52, v52, v34
    v_add_f32 v53, v53, v35
    v_add_f32 v52, v52, v36
    v_add_f32 v53, v53, v37
    v_add_f32 v52, v52, v38
    v_add_f32 v53, v53, v39
    v_add_f32 v52, v52, v40
    v_add_f32 v53, v53, v41
    v_add_f32 v52, v52, v42
    v_add_f32 v53, v53, v43
    v_add_f32 v52, v52, v44
    v_add_f32 v53, v53, v45
    v_add_f32 v52, v52, v46
    v_add_f32 v53, v53, v47
    v_add_f32 v52, v52, v48
    v_add_f32 v53, v53, v49
    v_add_f32 v52, v52, v50
    v_add_f32 v53, v53, v51
    v_add_f32 v52, v52, v53
    s_nop 1
    v_add_f32_dpp v54, v52, v52 row_ror:8 row_mask:0xf bank_mask:0xf
    v_mov_b32 v52, v54
    s_nop 1
    v_add_f32_dpp v54, v52, v52 row_ror:4 row_mask:0xf bank_mask:0xf
    v_mov_b32 v52, v54
    s_nop 1
    v_add_f32_dpp v54, v52, v52 row_ror:2 row_mask:0xf bank_mask:0xf
    v_mov_b32 v52, v54
    s_nop 1
    v_add_f32_dpp v54, v52, v52 row_ror:1 row_mask:0xf bank_mask:0xf
    v_mov_b32 v52, v54
    v_mul_f32 v52, 0x3b000000, v52
    v_mov_b32 v55, 0
    v_mov_b32 v56, 0
    v_sub_f32 v57, v20, v52
    v_sub_f32 v58, v21, v52
    v_fmac_f32 v55, v57, v57
    v_fmac_f32 v56, v58, v58
    v_sub_f32 v57, v22, v52
    v_sub_f32 v58, v23, v52
    v_fmac_f32 v55, v57, v57
    v_fmac_f32 v56, v58, v58
    v_sub_f32 v57, v24, v52
    v_sub_f32 v58, v25, v52
    v_fmac_f32 v55, v57, v57
    v_fmac_f32 v56, v58, v58
    v_sub_f32 v57, v26, v52
    v_sub_f32 v58, v27, v52
    v_fmac_f32 v55, v57, v57
    v_fmac_f32 v56, v58, v58
    v_sub_f32 v57, v28, v52
    v_sub_f32 v58, v29, v52
    v_fmac_f32 v55, v57, v57
    v_fmac_f32 v56, v58, v58
    v_sub_f32 v57, v30, v52
    v_sub_f32 v58, v31, v52
    v_fmac_f32 v55, v57, v57
    v_fmac_f32 v56, v58, v58
    v_sub_f32 v57, v32, v52
    v_sub_f32 v58, v33, v52
    v_fmac_f32 v55, v57, v57
    v_fmac_f32 v56, v58, v58
    v_sub_f32 v57, v34, v52
    v_sub_f32 v58, v35, v52
    v_fmac_f32 v55, v57, v57
    v_fmac_f32 v56, v58, v58
    v_sub_f32 v57, v36, v52
    v_sub_f32 v58, v37, v52
    v_fmac_f32 v55, v57, v57
    v_fmac_f32 v56, v58, v58
    v_sub_f32 v57, v38, v52
    v_sub_f32 v58, v39, v52
    v_fmac_f32 v55, v57, v57
    v_fmac_f32 v56, v58, v58
    v_sub_f32 v57, v40, v52
    v_sub_f32 v58, v41, v52
    v_fmac_f32 v55, v57, v57
    v_fmac_f32 v56, v58, v58
    v_sub_f32 v57, v42, v52
    v_sub_f32 v58, v43, v52
    v_fmac_f32 v55, v57, v57
    v_fmac_f32 v56, v58, v58
    v_sub_f32 v57, v44, v52
    v_sub_f32 v58, v45, v52
    v_fmac_f32 v55, v57, v57
    v_fmac_f32 v56, v58, v58
    v_sub_f32 v57, v46, v52
    v_sub_f32 v58, v47, v52
    v_fmac_f32 v55, v57, v57
    v_fmac_f32 v56, v58, v58
    v_sub_f32 v57, v48, v52
    v_sub_f32 v58, v49, v52
    v_fmac_f32 v55, v57, v57
    v_fmac_f32 v56, v58, v58
    v_sub_f32 v57, v50, v52
    v_sub_f32 v58, v51, v52
    v_fmac_f32 v55, v57, v57
    v_fmac_f32 v56, v58, v58
    v_add_f32 v55, v55, v56
    s_nop 1
    v_add_f32_dpp v54, v55, v55 row_ror:8 row_mask:0xf bank_mask:0xf
    v_mov_b32 v55, v54
    s_nop 1
    v_add_f32_dpp v54, v55, v55 row_ror:4 row_mask:0xf bank_mask:0xf
    v_mov_b32 v55, v54
    s_nop 1
    v_add_f32_dpp v54, v55, v55 row_ror:2 row_mask:0xf bank_mask:0xf
    v_mov_b32 v55, v54
    s_nop 1
    v_add_f32_dpp v54, v55, v55 row_ror:1 row_mask:0xf bank_mask:0xf
    v_mov_b32 v55, v54
    v_mul_f32 v55, 0x3b000000, v55
    v_cvt_pk_bf16_f32 v54, v52, v52
    v_lshlrev_b32 v52, 16, v54
    v_cvt_pk_bf16_f32 v54, v55, v55
    v_lshlrev_b32 v55, 16, v54
    v_add_f32 v55, 0x3727c5ac, v55
    v_cvt_pk_bf16_f32 v54, v55, v55
    v_lshlrev_b32 v55, 16, v54
    v_sqrt_f32 v55, v55
    s_nop 0
    v_cvt_pk_bf16_f32 v54, v55, v55
    v_lshlrev_b32 v55, 16, v54
    v_rcp_f32 v55, v55
    v_lshrrev_b32 v56, 2, v2
    v_lshlrev_b32 v56, 10, v56
    v_and_b32 v57, 3, v2
    v_lshl_add_u32 v56, v57, 8, v56
    v_lshl_add_u32 v56, v1, 4, v56
    v_sub_f32 v20, v20, v52
    v_sub_f32 v21, v21, v52
    v_cvt_pk_bf16_f32 v58, v20, v21
    v_lshlrev_b32 v20, 16, v58
    v_and_b32 v21, 0xffff0000, v58
    v_mul_f32 v20, v20, v55
    v_mul_f32 v21, v21, v55
    v_cvt_pk_bf16_f32 v4, v20, v21
    v_sub_f32 v22, v22, v52
    v_sub_f32 v23, v23, v52
    v_cvt_pk_bf16_f32 v58, v22, v23
    v_lshlrev_b32 v22, 16, v58
    v_and_b32 v23, 0xffff0000, v58
    v_mul_f32 v22, v22, v55
    v_mul_f32 v23, v23, v55
    v_cvt_pk_bf16_f32 v5, v22, v23
    v_sub_f32 v24, v24, v52
    v_sub_f32 v25, v25, v52
    v_cvt_pk_bf16_f32 v58, v24, v25
    v_lshlrev_b32 v24, 16, v58
    v_and_b32 v25, 0xffff0000, v58
    v_mul_f32 v24, v24, v55
    v_mul_f32 v25, v25, v55
    v_cvt_pk_bf16_f32 v6, v24, v25
    v_sub_f32 v26, v26, v52
    v_sub_f32 v27, v27, v52
    v_cvt_pk_bf16_f32 v58, v26, v27
    v_lshlrev_b32 v26, 16, v58
    v_and_b32 v27, 0xffff0000, v58
    v_mul_f32 v26, v26, v55
    v_mul_f32 v27, v27, v55
    v_cvt_pk_bf16_f32 v7, v26, v27
    buffer_store_dwordx4 v[4:7], v56, s[28:31], s60 offen sc1
    v_sub_f32 v28, v28, v52
    v_sub_f32 v29, v29, v52
    v_cvt_pk_bf16_f32 v58, v28, v29
    v_lshlrev_b32 v28, 16, v58
    v_and_b32 v29, 0xffff0000, v58
    v_mul_f32 v28, v28, v55
    v_mul_f32 v29, v29, v55
    v_cvt_pk_bf16_f32 v8, v28, v29
    v_sub_f32 v30, v30, v52
    v_sub_f32 v31, v31, v52
    v_cvt_pk_bf16_f32 v58, v30, v31
    v_lshlrev_b32 v30, 16, v58
    v_and_b32 v31, 0xffff0000, v58
    v_mul_f32 v30, v30, v55
    v_mul_f32 v31, v31, v55
    v_cvt_pk_bf16_f32 v9, v30, v31
    v_sub_f32 v32, v32, v52
    v_sub_f32 v33, v33, v52
    v_cvt_pk_bf16_f32 v58, v32, v33
    v_lshlrev_b32 v32, 16, v58
    v_and_b32 v33, 0xffff0000, v58
    v_mul_f32 v32, v32, v55
    v_mul_f32 v33, v33, v55
    v_cvt_pk_bf16_f32 v10, v32, v33
    v_sub_f32 v34, v34, v52
    v_sub_f32 v35, v35, v52
    v_cvt_pk_bf16_f32 v58, v34, v35
    v_lshlrev_b32 v34, 16, v58
    v_and_b32 v35, 0xffff0000, v58
    v_mul_f32 v34, v34, v55
    v_mul_f32 v35, v35, v55
    v_cvt_pk_bf16_f32 v11, v34, v35
    s_add_u32 s61, s60, 4096
    buffer_store_dwordx4 v[8:11], v56, s[28:31], s61 offen sc1
    v_sub_f32 v36, v36, v52
    v_sub_f32 v37, v37, v52
    v_cvt_pk_bf16_f32 v58, v36, v37
    v_lshlrev_b32 v36, 16, v58
    v_and_b32 v37, 0xffff0000, v58
    v_mul_f32 v36, v36, v55
    v_mul_f32 v37, v37, v55
    v_cvt_pk_bf16_f32 v12, v36, v37
    v_sub_f32 v38, v38, v52
    v_sub_f32 v39, v39, v52
    v_cvt_pk_bf16_f32 v58, v38, v39
    v_lshlrev_b32 v38, 16, v58
    v_and_b32 v39, 0xffff0000, v58
    v_mul_f32 v38, v38, v55
    v_mul_f32 v39, v39, v55
    v_cvt_pk_bf16_f32 v13, v38, v39
    v_sub_f32 v40, v40, v52
    v_sub_f32 v41, v41, v52
    v_cvt_pk_bf16_f32 v58, v40, v41
    v_lshlrev_b32 v40, 16, v58
    v_and_b32 v41, 0xffff0000, v58
    v_mul_f32 v40, v40, v55
    v_mul_f32 v41, v41, v55
    v_cvt_pk_bf16_f32 v14, v40, v41
    v_sub_f32 v42, v42, v52
    v_sub_f32 v43, v43, v52
    v_cvt_pk_bf16_f32 v58, v42, v43
    v_lshlrev_b32 v42, 16, v58
    v_and_b32 v43, 0xffff0000, v58
    v_mul_f32 v42, v42, v55
    v_mul_f32 v43, v43, v55
    v_cvt_pk_bf16_f32 v15, v42, v43
    s_add_u32 s61, s60, 8192
    buffer_store_dwordx4 v[12:15], v56, s[28:31], s61 offen sc1
    v_sub_f32 v44, v44, v52
    v_sub_f32 v45, v45, v52
    v_cvt_pk_bf16_f32 v58, v44, v45
    v_lshlrev_b32 v44, 16, v58
    v_and_b32 v45, 0xffff0000, v58
    v_mul_f32 v44, v44, v55
    v_mul_f32 v45, v45, v55
    v_cvt_pk_bf16_f32 v16, v44, v45
    v_sub_f32 v46, v46, v52
    v_sub_f32 v47, v47, v52
    v_cvt_pk_bf16_f32 v58, v46, v47
    v_lshlrev_b32 v46, 16, v58
    v_and_b32 v47, 0xffff0000, v58
    v_mul_f32 v46, v46, v55
    v_mul_f32 v47, v47, v55
    v_cvt_pk_bf16_f32 v17, v46, v47
    v_sub_f32 v48, v48, v52
    v_sub_f32 v49, v49, v52
    v_cvt_pk_bf16_f32 v58, v48, v49
    v_lshlrev_b32 v48, 16, v58
    v_and_b32 v49, 0xffff0000, v58
    v_mul_f32 v48, v48, v55
    v_mul_f32 v49, v49, v55
    v_cvt_pk_bf16_f32 v18, v48, v49
    v_sub_f32 v50, v50, v52
    v_sub_f32 v51, v51, v52
    v_cvt_pk_bf16_f32 v58, v50, v51
    v_lshlrev_b32 v50, 16, v58
    v_and_b32 v51, 0xffff0000, v58
    v_mul_f32 v50, v50, v55
    v_mul_f32 v51, v51, v55
    v_cvt_pk_bf16_f32 v19, v50, v51
    s_add_u32 s61, s60, 12288
    buffer_store_dwordx4 v[16:19], v56, s[28:31], s61 offen sc1
    s_branch K0_END
K0_SHUF0:
    v_lshrrev_b32 v1, 6, v0
    s_nop 0
    v_readfirstlane_b32 s60, v1
    s_sub_u32 s61, s2, 128
    s_and_b32 s62, s61, 15
    s_lshr_b32 s63, s61, 4
    s_lshl_b32 s63, s63, 2
    s_add_u32 s63, s63, s60
    s_mul_i32 s64, s62, 98304
    s_lshl_b32 s65, s63, 7
    s_add_u32 s64, s64, s65
    v_and_b32 v2, 63, v0
    v_lshrrev_b32 v3, 3, v2
    v_mul_u32_u24 v4, 3072, v3
    v_and_b32 v5, 7, v2
    v_lshl_add_u32 v4, v5, 4, v4
    buffer_load_dwordx4 v[8:11], v4, s[36:39], s64 offen
    s_add_u32 s64, s64, 24576
    buffer_load_dwordx4 v[12:15], v4, s[36:39], s64 offen
    s_add_u32 s64, s64, 24576
    buffer_load_dwordx4 v[16:19], v4, s[36:39], s64 offen
    s_add_u32 s64, s64, 24576
    buffer_load_dwordx4 v[20:23], v4, s[36:39], s64 offen
    s_mul_i32 s66, s60, 4608
    v_mul_u32_u24 v6, 144, v3
    v_lshl_add_u32 v6, v5, 4, v6
    v_add_u32 v6, s66, v6
    v_lshrrev_b32 v7, 4, v2
    v_bfe_u32 v24, v2, 2, 2
    v_lshlrev_b32 v7, 3, v7
    v_add_u32 v7, v7, v24
    v_mul_u32_u24 v7, 144, v7
    v_and_b32 v24, 3, v2
    v_lshl_add_u32 v7, v24, 3, v7
    v_add_u32 v7, s66, v7
    s_waitcnt vmcnt(3)
    ds_write_b128 v6, v[8:11] offset:0
    s_waitcnt vmcnt(2)
    ds_write_b128 v6, v[12:15] offset:1152
    s_waitcnt vmcnt(1)
    ds_write_b128 v6, v[16:19] offset:2304
    s_waitcnt vmcnt(0)
    ds_write_b128 v6, v[20:23] offset:3456
    s_mul_i32 s67, s63, 65536
    s_lshl_b32 s68, s62, 10
    s_add_u32 s67, s67, s68
    s_add_u32 s67, s67, 0x200000
    v_lshlrev_b32 v25, 4, v2
    ds_read_b64_tr_b16 v[28:29], v7 offset:0
    ds_read_b64_tr_b16 v[30:31], v7 offset:576
    ds_read_b64_tr_b16 v[32:33], v7 offset:32
    ds_read_b64_tr_b16 v[34:35], v7 offset:608
    ds_read_b64_tr_b16 v[36:37], v7 offset:64
    ds_read_b64_tr_b16 v[38:39], v7 offset:640
    ds_read_b64_tr_b16 v[40:41], v7 offset:96
    ds_read_b64_tr_b16 v[42:43], v7 offset:672
    s_waitcnt lgkmcnt(6)
    buffer_store_dwordx4 v[28:31], v25, s[28:31], s67 offen sc1
    s_add_u32 s67, s67, 16384
    s_waitcnt lgkmcnt(4)
    buffer_store_dwordx4 v[32:35], v25, s[28:31], s67 offen sc1
    s_add_u32 s67, s67, 16384
    s_waitcnt lgkmcnt(2)
    buffer_store_dwordx4 v[36:39], v25, s[28:31], s67 offen sc1
    s_add_u32 s67, s67, 16384
    s_waitcnt lgkmcnt(0)
    buffer_store_dwordx4 v[40:43], v25, s[28:31], s67 offen sc1
    s_branch K0_END
K0_SHUF1:
    v_lshrrev_b32 v1, 6, v0
    s_nop 0
    v_readfirstlane_b32 s60, v1
    s_sub_u32 s61, s2, 224
    s_and_b32 s62, s61, 15
    s_lshr_b32 s63, s61, 4
    s_lshl_b32 s63, s63, 2
    s_add_u32 s63, s63, s60
    s_mul_i32 s64, s62, 114688
    s_lshl_b32 s65, s63, 7
    s_add_u32 s64, s64, s65
    v_and_b32 v2, 63, v0
    v_lshrrev_b32 v3, 3, v2
    v_mul_u32_u24 v4, 3584, v3
    v_and_b32 v5, 7, v2
    v_lshl_add_u32 v4, v5, 4, v4
    buffer_load_dwordx4 v[8:11], v4, s[44:47], s64 offen
    s_add_u32 s64, s64, 28672
    buffer_load_dwordx4 v[12:15], v4, s[44:47], s64 offen
    s_add_u32 s64, s64, 28672
    buffer_load_dwordx4 v[16:19], v4, s[44:47], s64 offen
    s_add_u32 s64, s64, 28672
    buffer_load_dwordx4 v[20:23], v4, s[44:47], s64 offen
    s_mul_i32 s66, s60, 4608
    v_mul_u32_u24 v6, 144, v3
    v_lshl_add_u32 v6, v5, 4, v6
    v_add_u32 v6, s66, v6
    v_lshrrev_b32 v7, 4, v2
    v_bfe_u32 v24, v2, 2, 2
    v_lshlrev_b32 v7, 3, v7
    v_add_u32 v7, v7, v24
    v_mul_u32_u24 v7, 144, v7
    v_and_b32 v24, 3, v2
    v_lshl_add_u32 v7, v24, 3, v7
    v_add_u32 v7, s66, v7
    s_waitcnt vmcnt(3)
    ds_write_b128 v6, v[8:11] offset:0
    s_waitcnt vmcnt(2)
    ds_write_b128 v6, v[12:15] offset:1152
    s_waitcnt vmcnt(1)
    ds_write_b128 v6, v[16:19] offset:2304
    s_waitcnt vmcnt(0)
    ds_write_b128 v6, v[20:23] offset:3456
    s_mul_i32 s67, s63, 65536
    s_lshl_b32 s68, s62, 10
    s_add_u32 s67, s67, s68
    s_add_u32 s67, s67, 0x380000
    v_lshlrev_b32 v25, 4, v2
    ds_read_b64_tr_b16 v[28:29], v7 offset:0
    ds_read_b64_tr_b16 v[30:31], v7 offset:576
    ds_read_b64_tr_b16 v[32:33], v7 offset:32
    ds_read_b64_tr_b16 v[34:35], v7 offset:608
    ds_read_b64_tr_b16 v[36:37], v7 offset:64
    ds_read_b64_tr_b16 v[38:39], v7 offset:640
    ds_read_b64_tr_b16 v[40:41], v7 offset:96
    ds_read_b64_tr_b16 v[42:43], v7 offset:672
    s_waitcnt lgkmcnt(6)
    buffer_store_dwordx4 v[28:31], v25, s[28:31], s67 offen sc1
    s_add_u32 s67, s67, 16384
    s_waitcnt lgkmcnt(4)
    buffer_store_dwordx4 v[32:35], v25, s[28:31], s67 offen sc1
    s_add_u32 s67, s67, 16384
    s_waitcnt lgkmcnt(2)
    buffer_store_dwordx4 v[36:39], v25, s[28:31], s67 offen sc1
    s_add_u32 s67, s67, 16384
    s_waitcnt lgkmcnt(0)
    buffer_store_dwordx4 v[40:43], v25, s[28:31], s67 offen sc1
    s_branch K0_END
K0_SHUF2:
    v_lshrrev_b32 v1, 6, v0
    s_nop 0
    v_readfirstlane_b32 s60, v1
    s_sub_u32 s61, s2, 336
    s_and_b32 s62, s61, 15
    s_lshr_b32 s63, s61, 4
    s_lshl_b32 s63, s63, 2
    s_add_u32 s63, s63, s60
    s_mul_i32 s64, s62, 114688
    s_lshl_b32 s65, s63, 7
    s_add_u32 s64, s64, s65
    v_and_b32 v2, 63, v0
    v_lshrrev_b32 v3, 3, v2
    v_mul_u32_u24 v4, 3584, v3
    v_and_b32 v5, 7, v2
    v_lshl_add_u32 v4, v5, 4, v4
    buffer_load_dwordx4 v[8:11], v4, s[48:51], s64 offen
    s_add_u32 s64, s64, 28672
    buffer_load_dwordx4 v[12:15], v4, s[48:51], s64 offen
    s_add_u32 s64, s64, 28672
    buffer_load_dwordx4 v[16:19], v4, s[48:51], s64 offen
    s_add_u32 s64, s64, 28672
    buffer_load_dwordx4 v[20:23], v4, s[48:51], s64 offen
    s_mul_i32 s66, s60, 4608
    v_mul_u32_u24 v6, 144, v3
    v_lshl_add_u32 v6, v5, 4, v6
    v_add_u32 v6, s66, v6
    v_lshrrev_b32 v7, 4, v2
    v_bfe_u32 v24, v2, 2, 2
    v_lshlrev_b32 v7, 3, v7
    v_add_u32 v7, v7, v24
    v_mul_u32_u24 v7, 144, v7
    v_and_b32 v24, 3, v2
    v_lshl_add_u32 v7, v24, 3, v7
    v_add_u32 v7, s66, v7
    s_waitcnt vmcnt(3)
    ds_write_b128 v6, v[8:11] offset:0
    s_waitcnt vmcnt(2)
    ds_write_b128 v6, v[12:15] offset:1152
    s_waitcnt vmcnt(1)
    ds_write_b128 v6, v[16:19] offset:2304
    s_waitcnt vmcnt(0)
    ds_write_b128 v6, v[20:23] offset:3456
    s_mul_i32 s67, s63, 65536
    s_lshl_b32 s68, s62, 10
    s_add_u32 s67, s67, s68
    s_add_u32 s67, s67, 0x540000
    v_lshlrev_b32 v25, 4, v2
    ds_read_b64_tr_b16 v[28:29], v7 offset:0
    ds_read_b64_tr_b16 v[30:31], v7 offset:576
    ds_read_b64_tr_b16 v[32:33], v7 offset:32
    ds_read_b64_tr_b16 v[34:35], v7 offset:608
    ds_read_b64_tr_b16 v[36:37], v7 offset:64
    ds_read_b64_tr_b16 v[38:39], v7 offset:640
    ds_read_b64_tr_b16 v[40:41], v7 offset:96
    ds_read_b64_tr_b16 v[42:43], v7 offset:672
    s_waitcnt lgkmcnt(6)
    buffer_store_dwordx4 v[28:31], v25, s[28:31], s67 offen sc1
    s_add_u32 s67, s67, 16384
    s_waitcnt lgkmcnt(4)
    buffer_store_dwordx4 v[32:35], v25, s[28:31], s67 offen sc1
    s_add_u32 s67, s67, 16384
    s_waitcnt lgkmcnt(2)
    buffer_store_dwordx4 v[36:39], v25, s[28:31], s67 offen sc1
    s_add_u32 s67, s67, 16384
    s_waitcnt lgkmcnt(0)
    buffer_store_dwordx4 v[40:43], v25, s[28:31], s67 offen sc1
    s_branch K0_END
K0_SHUF3:
    v_lshrrev_b32 v1, 6, v0
    s_nop 0
    v_readfirstlane_b32 s60, v1
    s_sub_u32 s61, s2, 448
    s_and_b32 s63, s61, 1
    s_lshr_b32 s62, s61, 1
    s_lshl_b32 s63, s63, 2
    s_add_u32 s63, s63, s60
    s_mul_i32 s64, s62, 32768
    s_lshl_b32 s65, s63, 7
    s_add_u32 s64, s64, s65
    v_and_b32 v2, 63, v0
    v_lshrrev_b32 v3, 3, v2
    v_mul_u32_u24 v4, 1024, v3
    v_and_b32 v5, 7, v2
    v_lshl_add_u32 v4, v5, 4, v4
    buffer_load_dwordx4 v[8:11], v4, s[52:55], s64 offen
    s_add_u32 s64, s64, 8192
    buffer_load_dwordx4 v[12:15], v4, s[52:55], s64 offen
    s_add_u32 s64, s64, 8192
    buffer_load_dwordx4 v[16:19], v4, s[52:55], s64 offen
    s_add_u32 s64, s64, 8192
    buffer_load_dwordx4 v[20:23], v4, s[52:55], s64 offen
    s_mul_i32 s66, s60, 4608
    v_mul_u32_u24 v6, 144, v3
    v_lshl_add_u32 v6, v5, 4, v6
    v_add_u32 v6, s66, v6
    v_lshrrev_b32 v7, 4, v2
    v_bfe_u32 v24, v2, 2, 2
    v_lshlrev_b32 v7, 3, v7
    v_add_u32 v7, v7, v24
    v_mul_u32_u24 v7, 144, v7
    v_and_b32 v24, 3, v2
    v_lshl_add_u32 v7, v24, 3, v7
    v_add_u32 v7, s66, v7
    s_waitcnt vmcnt(3)
    ds_write_b128 v6, v[8:11] offset:0
    s_waitcnt vmcnt(2)
    ds_write_b128 v6, v[12:15] offset:1152
    s_waitcnt vmcnt(1)
    ds_write_b128 v6, v[16:19] offset:2304
    s_waitcnt vmcnt(0)
    ds_write_b128 v6, v[20:23] offset:3456
    s_mul_i32 s67, s63, 229376
    s_lshl_b32 s68, s62, 10
    s_add_u32 s67, s67, s68
    s_add_u32 s67, s67, 0x700000
    v_lshlrev_b32 v25, 4, v2
    ds_read_b64_tr_b16 v[28:29], v7 offset:0
    ds_read_b64_tr_b16 v[30:31], v7 offset:576
    ds_read_b64_tr_b16 v[32:33], v7 offset:32
    ds_read_b64_tr_b16 v[34:35], v7 offset:608
    ds_read_b64_tr_b16 v[36:37], v7 offset:64
    ds_read_b64_tr_b16 v[38:39], v7 offset:640
    ds_read_b64_tr_b16 v[40:41], v7 offset:96
    ds_read_b64_tr_b16 v[42:43], v7 offset:672
    s_waitcnt lgkmcnt(6)
    buffer_store_dwordx4 v[28:31], v25, s[28:31], s67 offen sc1
    s_add_u32 s67, s67, 57344
    s_waitcnt lgkmcnt(4)
    buffer_store_dwordx4 v[32:35], v25, s[28:31], s67 offen sc1
    s_add_u32 s67, s67, 57344
    s_waitcnt lgkmcnt(2)
    buffer_store_dwordx4 v[36:39], v25, s[28:31], s67 offen sc1
    s_add_u32 s67, s67, 57344
    s_waitcnt lgkmcnt(0)
    buffer_store_dwordx4 v[40:43], v25, s[28:31], s67 offen sc1
    s_branch K0_END
K0_SHUF4:
    v_lshrrev_b32 v1, 6, v0
    s_nop 0
    v_readfirstlane_b32 s60, v1
    s_sub_u32 s61, s2, 560
    s_and_b32 s62, s61, 15
    s_lshr_b32 s63, s61, 4
    s_lshl_b32 s63, s63, 2
    s_add_u32 s63, s63, s60
    s_mul_i32 s64, s62, 32768
    s_lshl_b32 s65, s63, 7
    s_add_u32 s64, s64, s65
    v_and_b32 v2, 63, v0
    v_lshrrev_b32 v3, 3, v2
    v_mul_u32_u24 v4, 1024, v3
    v_and_b32 v5, 7, v2
    v_lshl_add_u32 v4, v5, 4, v4
    buffer_load_dwordx4 v[8:11], v4, s[40:43], s64 offen
    s_add_u32 s64, s64, 8192
    buffer_load_dwordx4 v[12:15], v4, s[40:43], s64 offen
    s_add_u32 s64, s64, 8192
    buffer_load_dwordx4 v[16:19], v4, s[40:43], s64 offen
    s_add_u32 s64, s64, 8192
    buffer_load_dwordx4 v[20:23], v4, s[40:43], s64 offen
    s_mul_i32 s66, s60, 4608
    v_mul_u32_u24 v6, 144, v3
    v_lshl_add_u32 v6, v5, 4, v6
    v_add_u32 v6, s66, v6
    v_lshrrev_b32 v7, 4, v2
    v_bfe_u32 v24, v2, 2, 2
    v_lshlrev_b32 v7, 2, v7
    v_add_u32 v7, v7, v24
    v_mul_u32_u24 v7, 144, v7
    v_and_b32 v24, 3, v2
    v_lshl_add_u32 v7, v24, 3, v7
    v_add_u32 v7, s66, v7
    s_waitcnt vmcnt(3)
    ds_write_b128 v6, v[8:11] offset:0
    s_waitcnt vmcnt(2)
    ds_write_b128 v6, v[12:15] offset:1152
    s_waitcnt vmcnt(1)
    ds_write_b128 v6, v[16:19] offset:2304
    s_waitcnt vmcnt(0)
    ds_write_b128 v6, v[20:23] offset:3456
    s_mul_i32 s67, s63, 65536
    s_lshl_b32 s68, s62, 10
    s_add_u32 s67, s67, s68
    s_add_u32 s67, s67, 0x900000
    v_lshlrev_b32 v25, 4, v2
    ds_read_b64_tr_b16 v[28:29], v7 offset:0
    ds_read_b64_tr_b16 v[30:31], v7 offset:2304
    ds_read_b64_tr_b16 v[32:33], v7 offset:32
    ds_read_b64_tr_b16 v[34:35], v7 offset:2336
    ds_read_b64_tr_b16 v[36:37], v7 offset:64
    ds_read_b64_tr_b16 v[38:39], v7 offset:2368
    ds_read_b64_tr_b16 v[40:41], v7 offset:96
    ds_read_b64_tr_b16 v[42:43], v7 offset:2400
    s_waitcnt lgkmcnt(6)
    buffer_store_dwordx4 v[28:31], v25, s[28:31], s67 offen sc1
    s_add_u32 s67, s67, 16384
    s_waitcnt lgkmcnt(4)
    buffer_store_dwordx4 v[32:35], v25, s[28:31], s67 offen sc1
    s_add_u32 s67, s67, 16384
    s_waitcnt lgkmcnt(2)
    buffer_store_dwordx4 v[36:39], v25, s[28:31], s67 offen sc1
    s_add_u32 s67, s67, 16384
    s_waitcnt lgkmcnt(0)
    buffer_store_dwordx4 v[40:43], v25, s[28:31], s67 offen sc1
    s_branch K0_END
K0_END:
    s_endpgm
.text
.globl k1_gemm_kernel
.p2align 8
.type k1_gemm_kernel,@function
k1_gemm_kernel:
    s_cmp_ge_u32 s2, 256
    s_cbranch_scc1 K1_END
    s_load_dwordx8 s[8:15], s[0:1], 0
    s_load_dwordx8 s[16:23], s[0:1], 32
    s_load_dwordx4 s[24:27], s[0:1], 64
    s_waitcnt lgkmcnt(0)
    s_mov_b32 s28, s26
    s_and_b32 s29, s27, 0xffff
    s_mov_b32 s30, 0x1400000
    s_mov_b32 s31, 0x00020000
    s_lshr_b32 s32, s2, 5
    s_and_b32 s33, s2, 31
    v_lshrrev_b32 v11, 6, v0
    s_nop 0
    v_readfirstlane_b32 s34, v11
    v_and_b32 v11, 63, v0
    v_lshlrev_b32 v1, 4, v11
    s_lshl_b32 s55, s32, 4
    s_lshl_b32 s56, s34, 1
    s_add_u32 s55, s55, s56
    s_lshl_b32 s56, s55, 14
    v_add_u32 v2, s56, v1
    v_add_u32 v3, 16384, v2
    v_mov_b32 v4, v1
    v_add_u32 v5, 40960, v1
    s_mov_b32 s52, 4096
    s_mov_b32 s53, 8192
    s_mov_b32 s54, 12288
    s_mul_i32 s58, s55, 57344
    s_add_u32 s58, s58, 0xc00000
    s_lshl_b32 s59, s55, 14
    s_add_u32 s59, s59, 0xa00000
    s_cmp_lt_u32 s33, 16
    s_cbranch_scc1 K1_V_Q1K1F3
    s_branch K1_V_K1F4
K1_V_Q1K1F3:
    s_mul_i32 s36, s33, 32768
    s_add_u32 s36, s36, 0x200000
    s_mul_i32 s37, s33, 32768
    s_add_u32 s37, s37, 0x204000
    s_mul_i32 s38, s33, 16384
    s_add_u32 s38, s38, 0x280000
    s_mul_i32 s39, s33, 16384
    s_add_u32 s39, s39, 0x300000
    s_mul_i32 s40, s33, 49152
    s_add_u32 s40, s40, 0x380000
    s_mul_i32 s41, s33, 49152
    s_add_u32 s41, s41, 0x540000
    s_mul_i32 s42, s33, 49152
    s_add_u32 s42, s42, 0x384000
    s_mul_i32 s43, s33, 49152
    s_add_u32 s43, s43, 0x544000
    s_mul_i32 s44, s33, 49152
    s_add_u32 s44, s44, 0x388000
    s_mul_i32 s45, s33, 49152
    s_add_u32 s45, s45, 0x548000
    s_lshr_b32 s55, s34, 1
    s_lshl_b32 s56, s55, 10
    s_mul_i32 s51, s55, 10240
    s_and_b32 s57, s34, 1
    s_cselect_b32 s46, s41, s36
    s_cselect_b32 s47, s42, s37
    s_cselect_b32 s48, s43, s38
    s_cselect_b32 s49, s44, s39
    s_cselect_b32 s50, s45, s40
    s_add_u32 s46, s46, s56
    s_add_u32 s47, s47, s56
    s_add_u32 s48, s48, s56
    s_add_u32 s49, s49, s56
    s_add_u32 s50, s50, s56
    s_mul_i32 s57, s57, 5120
    s_add_u32 s51, s51, s57
    s_add_u32 m0, s51, 0
    s_add_u32 s55, s46, 0
    buffer_load_dwordx4 v1, s[28:31], s55 offen lds
    s_add_u32 m0, s51, 1024
    s_add_u32 s55, s47, 0
    buffer_load_dwordx4 v1, s[28:31], s55 offen lds
    s_add_u32 m0, s51, 2048
    s_add_u32 s55, s48, 0
    buffer_load_dwordx4 v1, s[28:31], s55 offen lds
    s_add_u32 m0, s51, 3072
    s_add_u32 s55, s49, 0
    buffer_load_dwordx4 v1, s[28:31], s55 offen lds
    s_add_u32 m0, s51, 4096
    s_add_u32 s55, s50, 0
    buffer_load_dwordx4 v1, s[28:31], s55 offen lds
    s_add_u32 m0, s51, 40960
    s_add_u32 s55, s46, 4096
    buffer_load_dwordx4 v1, s[28:31], s55 offen lds
    s_add_u32 m0, s51, 41984
    s_add_u32 s55, s47, 4096
    buffer_load_dwordx4 v1, s[28:31], s55 offen lds
    s_add_u32 m0, s51, 43008
    s_add_u32 s55, s48, 4096
    buffer_load_dwordx4 v1, s[28:31], s55 offen lds
    s_add_u32 m0, s51, 44032
    s_add_u32 s55, s49, 4096
    buffer_load_dwordx4 v1, s[28:31], s55 offen lds
    s_add_u32 m0, s51, 45056
    s_add_u32 s55, s50, 4096
    buffer_load_dwordx4 v1, s[28:31], s55 offen lds
    buffer_load_dwordx4 v[96:99], v2, s[28:31], 0 offen offset:0
    buffer_load_dwordx4 v[100:103], v3, s[28:31], 0 offen offset:0
    buffer_load_dwordx4 v[104:107], v2, s[28:31], 0 offen offset:1024
    buffer_load_dwordx4 v[108:111], v3, s[28:31], 0 offen offset:1024
    s_waitcnt vmcnt(9)
    s_barrier
    ds_read_b128 v[120:123], v4 offset:0
    ds_read_b128 v[124:127], v4 offset:1024
    ds_read_b128 v[128:131], v4 offset:2048
    ds_read_b128 v[132:135], v4 offset:3072
    ds_read_b128 v[136:139], v4 offset:4096
    buffer_load_dwordx4 v[112:115], v2, s[28:31], 0 offen offset:2048
    buffer_load_dwordx4 v[116:119], v3, s[28:31], 0 offen offset:2048
    ds_read_b128 v[140:143], v4 offset:5120
    ds_read_b128 v[144:147], v4 offset:6144
    ds_read_b128 v[148:151], v4 offset:7168
    ds_read_b128 v[152:155], v4 offset:8192
    ds_read_b128 v[156:159], v4 offset:9216
    s_waitcnt vmcnt(5)
    s_waitcnt lgkmcnt(9)
    v_mfma_f32_16x16x32_bf16 v[16:19], v[120:123], v[96:99], 0
    s_waitcnt vmcnt(4)
    v_mfma_f32_16x16x32_bf16 v[20:23], v[120:123], v[100:103], 0
    s_waitcnt lgkmcnt(8)
    v_mfma_f32_16x16x32_bf16 v[24:27], v[124:127], v[96:99], 0
    v_mfma_f32_16x16x32_bf16 v[28:31], v[124:127], v[100:103], 0
    s_waitcnt lgkmcnt(7)
    v_mfma_f32_16x16x32_bf16 v[32:35], v[96:99], v[128:131], 0
    v_mfma_f32_16x16x32_bf16 v[36:39], v[100:103], v[128:131], 0
    s_waitcnt lgkmcnt(6)
    v_mfma_f32_16x16x32_bf16 v[40:43], v[96:99], v[132:135], 0
    v_mfma_f32_16x16x32_bf16 v[44:47], v[100:103], v[132:135], 0
    s_waitcnt lgkmcnt(5)
    v_mfma_f32_16x16x32_bf16 v[48:51], v[136:139], v[96:99], 0
    v_mfma_f32_16x16x32_bf16 v[52:55], v[136:139], v[100:103], 0
    ds_read_b128 v[120:123], v4 offset:10240
    ds_read_b128 v[124:127], v4 offset:11264
    ds_read_b128 v[128:131], v4 offset:12288
    ds_read_b128 v[132:135], v4 offset:13312
    ds_read_b128 v[136:139], v4 offset:14336
    s_waitcnt lgkmcnt(9)
    v_mfma_f32_16x16x32_bf16 v[56:59], v[140:143], v[96:99], 0
    v_mfma_f32_16x16x32_bf16 v[60:63], v[140:143], v[100:103], 0
    s_waitcnt lgkmcnt(8)
    v_mfma_f32_16x16x32_bf16 v[64:67], v[144:147], v[96:99], 0
    v_mfma_f32_16x16x32_bf16 v[68:71], v[144:147], v[100:103], 0
    s_waitcnt lgkmcnt(7)
    v_mfma_f32_16x16x32_bf16 v[72:75], v[148:151], v[96:99], 0
    v_mfma_f32_16x16x32_bf16 v[76:79], v[148:151], v[100:103], 0
    s_waitcnt lgkmcnt(6)
    v_mfma_f32_16x16x32_bf16 v[80:83], v[152:155], v[96:99], 0
    v_mfma_f32_16x16x32_bf16 v[84:87], v[152:155], v[100:103], 0
    s_waitcnt lgkmcnt(5)
    v_mfma_f32_16x16x32_bf16 v[88:91], v[156:159], v[96:99], 0
    v_mfma_f32_16x16x32_bf16 v[92:95], v[156:159], v[100:103], 0
    buffer_load_dwordx4 v[96:99], v2, s[28:31], 0 offen offset:3072
    buffer_load_dwordx4 v[100:103], v3, s[28:31], 0 offen offset:3072
    ds_read_b128 v[140:143], v4 offset:15360
    ds_read_b128 v[144:147], v4 offset:16384
    ds_read_b128 v[148:151], v4 offset:17408
    ds_read_b128 v[152:155], v4 offset:18432
    ds_read_b128 v[156:159], v4 offset:19456
    s_waitcnt vmcnt(5)
    s_waitcnt lgkmcnt(9)
    v_mfma_f32_16x16x32_bf16 v[16:19], v[120:123], v[104:107], v[16:19]
    s_waitcnt vmcnt(4)
    v_mfma_f32_16x16x32_bf16 v[20:23], v[120:123], v[108:111], v[20:23]
    s_waitcnt lgkmcnt(8)
    v_mfma_f32_16x16x32_bf16 v[24:27], v[124:127], v[104:107], v[24:27]
    v_mfma_f32_16x16x32_bf16 v[28:31], v[124:127], v[108:111], v[28:31]
    s_waitcnt lgkmcnt(7)
    v_mfma_f32_16x16x32_bf16 v[32:35], v[104:107], v[128:131], v[32:35]
    v_mfma_f32_16x16x32_bf16 v[36:39], v[108:111], v[128:131], v[36:39]
    s_waitcnt lgkmcnt(6)
    v_mfma_f32_16x16x32_bf16 v[40:43], v[104:107], v[132:135], v[40:43]
    v_mfma_f32_16x16x32_bf16 v[44:47], v[108:111], v[132:135], v[44:47]
    s_waitcnt lgkmcnt(5)
    v_mfma_f32_16x16x32_bf16 v[48:51], v[136:139], v[104:107], v[48:51]
    v_mfma_f32_16x16x32_bf16 v[52:55], v[136:139], v[108:111], v[52:55]
    ds_read_b128 v[120:123], v4 offset:20480
    ds_read_b128 v[124:127], v4 offset:21504
    ds_read_b128 v[128:131], v4 offset:22528
    ds_read_b128 v[132:135], v4 offset:23552
    ds_read_b128 v[136:139], v4 offset:24576
    s_waitcnt lgkmcnt(9)
    v_mfma_f32_16x16x32_bf16 v[56:59], v[140:143], v[104:107], v[56:59]
    v_mfma_f32_16x16x32_bf16 v[60:63], v[140:143], v[108:111], v[60:63]
    s_waitcnt lgkmcnt(8)
    v_mfma_f32_16x16x32_bf16 v[64:67], v[144:147], v[104:107], v[64:67]
    v_mfma_f32_16x16x32_bf16 v[68:71], v[144:147], v[108:111], v[68:71]
    s_waitcnt lgkmcnt(7)
    v_mfma_f32_16x16x32_bf16 v[72:75], v[148:151], v[104:107], v[72:75]
    v_mfma_f32_16x16x32_bf16 v[76:79], v[148:151], v[108:111], v[76:79]
    s_waitcnt lgkmcnt(6)
    v_mfma_f32_16x16x32_bf16 v[80:83], v[152:155], v[104:107], v[80:83]
    v_mfma_f32_16x16x32_bf16 v[84:87], v[152:155], v[108:111], v[84:87]
    s_waitcnt lgkmcnt(5)
    v_mfma_f32_16x16x32_bf16 v[88:91], v[156:159], v[104:107], v[88:91]
    v_mfma_f32_16x16x32_bf16 v[92:95], v[156:159], v[108:111], v[92:95]
    buffer_load_dwordx4 v[104:107], v2, s[28:31], s52 offen offset:0
    buffer_load_dwordx4 v[108:111], v3, s[28:31], s52 offen offset:0
    ds_read_b128 v[140:143], v4 offset:25600
    ds_read_b128 v[144:147], v4 offset:26624
    ds_read_b128 v[148:151], v4 offset:27648
    ds_read_b128 v[152:155], v4 offset:28672
    ds_read_b128 v[156:159], v4 offset:29696
    s_waitcnt vmcnt(5)
    s_waitcnt lgkmcnt(9)
    v_mfma_f32_16x16x32_bf16 v[16:19], v[120:123], v[112:115], v[16:19]
    s_waitcnt vmcnt(4)
    v_mfma_f32_16x16x32_bf16 v[20:23], v[120:123], v[116:119], v[20:23]
    s_waitcnt lgkmcnt(8)
    v_mfma_f32_16x16x32_bf16 v[24:27], v[124:127], v[112:115], v[24:27]
    v_mfma_f32_16x16x32_bf16 v[28:31], v[124:127], v[116:119], v[28:31]
    s_waitcnt lgkmcnt(7)
    v_mfma_f32_16x16x32_bf16 v[32:35], v[112:115], v[128:131], v[32:35]
    v_mfma_f32_16x16x32_bf16 v[36:39], v[116:119], v[128:131], v[36:39]
    s_waitcnt lgkmcnt(6)
    v_mfma_f32_16x16x32_bf16 v[40:43], v[112:115], v[132:135], v[40:43]
    v_mfma_f32_16x16x32_bf16 v[44:47], v[116:119], v[132:135], v[44:47]
    s_waitcnt lgkmcnt(5)
    v_mfma_f32_16x16x32_bf16 v[48:51], v[136:139], v[112:115], v[48:51]
    v_mfma_f32_16x16x32_bf16 v[52:55], v[136:139], v[116:119], v[52:55]
    ds_read_b128 v[120:123], v4 offset:30720
    ds_read_b128 v[124:127], v4 offset:31744
    ds_read_b128 v[128:131], v4 offset:32768
    ds_read_b128 v[132:135], v4 offset:33792
    ds_read_b128 v[136:139], v4 offset:34816
    s_waitcnt lgkmcnt(9)
    v_mfma_f32_16x16x32_bf16 v[56:59], v[140:143], v[112:115], v[56:59]
    v_mfma_f32_16x16x32_bf16 v[60:63], v[140:143], v[116:119], v[60:63]
    s_waitcnt lgkmcnt(8)
    v_mfma_f32_16x16x32_bf16 v[64:67], v[144:147], v[112:115], v[64:67]
    v_mfma_f32_16x16x32_bf16 v[68:71], v[144:147], v[116:119], v[68:71]
    s_waitcnt lgkmcnt(7)
    v_mfma_f32_16x16x32_bf16 v[72:75], v[148:151], v[112:115], v[72:75]
    v_mfma_f32_16x16x32_bf16 v[76:79], v[148:151], v[116:119], v[76:79]
    s_waitcnt lgkmcnt(6)
    v_mfma_f32_16x16x32_bf16 v[80:83], v[152:155], v[112:115], v[80:83]
    v_mfma_f32_16x16x32_bf16 v[84:87], v[152:155], v[116:119], v[84:87]
    s_waitcnt lgkmcnt(5)
    v_mfma_f32_16x16x32_bf16 v[88:91], v[156:159], v[112:115], v[88:91]
    v_mfma_f32_16x16x32_bf16 v[92:95], v[156:159], v[116:119], v[92:95]
    buffer_load_dwordx4 v[112:115], v2, s[28:31], s52 offen offset:1024
    buffer_load_dwordx4 v[116:119], v3, s[28:31], s52 offen offset:1024
    ds_read_b128 v[140:143], v4 offset:35840
    ds_read_b128 v[144:147], v4 offset:36864
    ds_read_b128 v[148:151], v4 offset:37888
    ds_read_b128 v[152:155], v4 offset:38912
    ds_read_b128 v[156:159], v4 offset:39936
    s_waitcnt vmcnt(5)
    s_waitcnt lgkmcnt(9)
    v_mfma_f32_16x16x32_bf16 v[16:19], v[120:123], v[96:99], v[16:19]
    s_waitcnt vmcnt(4)
    v_mfma_f32_16x16x32_bf16 v[20:23], v[120:123], v[100:103], v[20:23]
    s_waitcnt lgkmcnt(8)
    v_mfma_f32_16x16x32_bf16 v[24:27], v[124:127], v[96:99], v[24:27]
    v_mfma_f32_16x16x32_bf16 v[28:31], v[124:127], v[100:103], v[28:31]
    s_waitcnt lgkmcnt(7)
    v_mfma_f32_16x16x32_bf16 v[32:35], v[96:99], v[128:131], v[32:35]
    v_mfma_f32_16x16x32_bf16 v[36:39], v[100:103], v[128:131], v[36:39]
    s_waitcnt lgkmcnt(6)
    v_mfma_f32_16x16x32_bf16 v[40:43], v[96:99], v[132:135], v[40:43]
    v_mfma_f32_16x16x32_bf16 v[44:47], v[100:103], v[132:135], v[44:47]
    s_waitcnt lgkmcnt(5)
    v_mfma_f32_16x16x32_bf16 v[48:51], v[136:139], v[96:99], v[48:51]
    v_mfma_f32_16x16x32_bf16 v[52:55], v[136:139], v[100:103], v[52:55]
    s_waitcnt lgkmcnt(4)
    v_mfma_f32_16x16x32_bf16 v[56:59], v[140:143], v[96:99], v[56:59]
    v_mfma_f32_16x16x32_bf16 v[60:63], v[140:143], v[100:103], v[60:63]
    s_waitcnt lgkmcnt(3)
    v_mfma_f32_16x16x32_bf16 v[64:67], v[144:147], v[96:99], v[64:67]
    v_mfma_f32_16x16x32_bf16 v[68:71], v[144:147], v[100:103], v[68:71]
    s_waitcnt lgkmcnt(2)
    v_mfma_f32_16x16x32_bf16 v[72:75], v[148:151], v[96:99], v[72:75]
    v_mfma_f32_16x16x32_bf16 v[76:79], v[148:151], v[100:103], v[76:79]
    s_waitcnt lgkmcnt(1)
    v_mfma_f32_16x16x32_bf16 v[80:83], v[152:155], v[96:99], v[80:83]
    v_mfma_f32_16x16x32_bf16 v[84:87], v[152:155], v[100:103], v[84:87]
    s_waitcnt lgkmcnt(0)
    v_mfma_f32_16x16x32_bf16 v[88:91], v[156:159], v[96:99], v[88:91]
    v_mfma_f32_16x16x32_bf16 v[92:95], v[156:159], v[100:103], v[92:95]
    s_barrier
    ds_read_b128 v[120:123], v5 offset:0
    ds_read_b128 v[124:127], v5 offset:1024
    ds_read_b128 v[128:131], v5 offset:2048
    ds_read_b128 v[132:135], v5 offset:3072
    ds_read_b128 v[136:139], v5 offset:4096
    s_add_u32 m0, s51, 0
    s_add_u32 s55, s46, 8192
    buffer_load_dwordx4 v1, s[28:31], s55 offen lds
    s_add_u32 m0, s51, 1024
    s_add_u32 s55, s47, 8192
    buffer_load_dwordx4 v1, s[28:31], s55 offen lds
    s_add_u32 m0, s51, 2048
    s_add_u32 s55, s48, 8192
    buffer_load_dwordx4 v1, s[28:31], s55 offen lds
    s_add_u32 m0, s51, 3072
    s_add_u32 s55, s49, 8192
    buffer_load_dwordx4 v1, s[28:31], s55 offen lds
    s_add_u32 m0, s51, 4096
    s_add_u32 s55, s50, 8192
    buffer_load_dwordx4 v1, s[28:31], s55 offen lds
    buffer_load_dwordx4 v[96:99], v2, s[28:31], s52 offen offset:2048
    buffer_load_dwordx4 v[100:103], v3, s[28:31], s52 offen offset:2048
    ds_read_b128 v[140:143], v5 offset:5120
    ds_read_b128 v[144:147], v5 offset:6144
    ds_read_b128 v[148:151], v5 offset:7168
    ds_read_b128 v[152:155], v5 offset:8192
    ds_read_b128 v[156:159], v5 offset:9216
    s_waitcnt vmcnt(10)
    s_waitcnt lgkmcnt(9)
    v_mfma_f32_16x16x32_bf16 v[16:19], v[120:123], v[104:107], v[16:19]
    s_waitcnt vmcnt(9)
    v_mfma_f32_16x16x32_bf16 v[20:23], v[120:123], v[108:111], v[20:23]
    s_waitcnt lgkmcnt(8)
    v_mfma_f32_16x16x32_bf16 v[24:27], v[124:127], v[104:107], v[24:27]
    v_mfma_f32_16x16x32_bf16 v[28:31], v[124:127], v[108:111], v[28:31]
    s_waitcnt lgkmcnt(7)
    v_mfma_f32_16x16x32_bf16 v[32:35], v[104:107], v[128:131], v[32:35]
    v_mfma_f32_16x16x32_bf16 v[36:39], v[108:111], v[128:131], v[36:39]
    s_waitcnt lgkmcnt(6)
    v_mfma_f32_16x16x32_bf16 v[40:43], v[104:107], v[132:135], v[40:43]
    v_mfma_f32_16x16x32_bf16 v[44:47], v[108:111], v[132:135], v[44:47]
    s_waitcnt lgkmcnt(5)
    v_mfma_f32_16x16x32_bf16 v[48:51], v[136:139], v[104:107], v[48:51]
    v_mfma_f32_16x16x32_bf16 v[52:55], v[136:139], v[108:111], v[52:55]
    ds_read_b128 v[120:123], v5 offset:10240
    ds_read_b128 v[124:127], v5 offset:11264
    ds_read_b128 v[128:131], v5 offset:12288
    ds_read_b128 v[132:135], v5 offset:13312
    ds_read_b128 v[136:139], v5 offset:14336
    s_waitcnt lgkmcnt(9)
    v_mfma_f32_16x16x32_bf16 v[56:59], v[140:143], v[104:107], v[56:59]
    v_mfma_f32_16x16x32_bf16 v[60:63], v[140:143], v[108:111], v[60:63]
    s_waitcnt lgkmcnt(8)
    v_mfma_f32_16x16x32_bf16 v[64:67], v[144:147], v[104:107], v[64:67]
    v_mfma_f32_16x16x32_bf16 v[68:71], v[144:147], v[108:111], v[68:71]
    s_waitcnt lgkmcnt(7)
    v_mfma_f32_16x16x32_bf16 v[72:75], v[148:151], v[104:107], v[72:75]
    v_mfma_f32_16x16x32_bf16 v[76:79], v[148:151], v[108:111], v[76:79]
    s_waitcnt lgkmcnt(6)
    v_mfma_f32_16x16x32_bf16 v[80:83], v[152:155], v[104:107], v[80:83]
    v_mfma_f32_16x16x32_bf16 v[84:87], v[152:155], v[108:111], v[84:87]
    s_waitcnt lgkmcnt(5)
    v_mfma_f32_16x16x32_bf16 v[88:91], v[156:159], v[104:107], v[88:91]
    v_mfma_f32_16x16x32_bf16 v[92:95], v[156:159], v[108:111], v[92:95]
    buffer_load_dwordx4 v[104:107], v2, s[28:31], s52 offen offset:3072
    buffer_load_dwordx4 v[108:111], v3, s[28:31], s52 offen offset:3072
    ds_read_b128 v[140:143], v5 offset:15360
    ds_read_b128 v[144:147], v5 offset:16384
    ds_read_b128 v[148:151], v5 offset:17408
    ds_read_b128 v[152:155], v5 offset:18432
    ds_read_b128 v[156:159], v5 offset:19456
    s_waitcnt vmcnt(10)
    s_waitcnt lgkmcnt(9)
    v_mfma_f32_16x16x32_bf16 v[16:19], v[120:123], v[112:115], v[16:19]
    s_waitcnt vmcnt(9)
    v_mfma_f32_16x16x32_bf16 v[20:23], v[120:123], v[116:119], v[20:23]
    s_waitcnt lgkmcnt(8)
    v_mfma_f32_16x16x32_bf16 v[24:27], v[124:127], v[112:115], v[24:27]
    v_mfma_f32_16x16x32_bf16 v[28:31], v[124:127], v[116:119], v[28:31]
    s_waitcnt lgkmcnt(7)
    v_mfma_f32_16x16x32_bf16 v[32:35], v[112:115], v[128:131], v[32:35]
    v_mfma_f32_16x16x32_bf16 v[36:39], v[116:119], v[128:131], v[36:39]
    s_waitcnt lgkmcnt(6)
    v_mfma_f32_16x16x32_bf16 v[40:43], v[112:115], v[132:135], v[40:43]
    v_mfma_f32_16x16x32_bf16 v[44:47], v[116:119], v[132:135], v[44:47]
    s_waitcnt lgkmcnt(5)
    v_mfma_f32_16x16x32_bf16 v[48:51], v[136:139], v[112:115], v[48:51]
    v_mfma_f32_16x16x32_bf16 v[52:55], v[136:139], v[116:119], v[52:55]
    ds_read_b128 v[120:123], v5 offset:20480
    ds_read_b128 v[124:127], v5 offset:21504
    ds_read_b128 v[128:131], v5 offset:22528
    ds_read_b128 v[132:135], v5 offset:23552
    ds_read_b128 v[136:139], v5 offset:24576
    s_waitcnt lgkmcnt(9)
    v_mfma_f32_16x16x32_bf16 v[56:59], v[140:143], v[112:115], v[56:59]
    v_mfma_f32_16x16x32_bf16 v[60:63], v[140:143], v[116:119], v[60:63]
    s_waitcnt lgkmcnt(8)
    v_mfma_f32_16x16x32_bf16 v[64:67], v[144:147], v[112:115], v[64:67]
    v_mfma_f32_16x16x32_bf16 v[68:71], v[144:147], v[116:119], v[68:71]
    s_waitcnt lgkmcnt(7)
    v_mfma_f32_16x16x32_bf16 v[72:75], v[148:151], v[112:115], v[72:75]
    v_mfma_f32_16x16x32_bf16 v[76:79], v[148:151], v[116:119], v[76:79]
    s_waitcnt lgkmcnt(6)
    v_mfma_f32_16x16x32_bf16 v[80:83], v[152:155], v[112:115], v[80:83]
    v_mfma_f32_16x16x32_bf16 v[84:87], v[152:155], v[116:119], v[84:87]
    s_waitcnt lgkmcnt(5)
    v_mfma_f32_16x16x32_bf16 v[88:91], v[156:159], v[112:115], v[88:91]
    v_mfma_f32_16x16x32_bf16 v[92:95], v[156:159], v[116:119], v[92:95]
    buffer_load_dwordx4 v[112:115], v2, s[28:31], s53 offen offset:0
    buffer_load_dwordx4 v[116:119], v3, s[28:31], s53 offen offset:0
    ds_read_b128 v[140:143], v5 offset:25600
    ds_read_b128 v[144:147], v5 offset:26624
    ds_read_b128 v[148:151], v5 offset:27648
    ds_read_b128 v[152:155], v5 offset:28672
    ds_read_b128 v[156:159], v5 offset:29696
    s_waitcnt vmcnt(5)
    s_waitcnt lgkmcnt(9)
    v_mfma_f32_16x16x32_bf16 v[16:19], v[120:123], v[96:99], v[16:19]
    s_waitcnt vmcnt(4)
    v_mfma_f32_16x16x32_bf16 v[20:23], v[120:123], v[100:103], v[20:23]
    s_waitcnt lgkmcnt(8)
    v_mfma_f32_16x16x32_bf16 v[24:27], v[124:127], v[96:99], v[24:27]
    v_mfma_f32_16x16x32_bf16 v[28:31], v[124:127], v[100:103], v[28:31]
    s_waitcnt lgkmcnt(7)
    v_mfma_f32_16x16x32_bf16 v[32:35], v[96:99], v[128:131], v[32:35]
    v_mfma_f32_16x16x32_bf16 v[36:39], v[100:103], v[128:131], v[36:39]
    s_waitcnt lgkmcnt(6)
    v_mfma_f32_16x16x32_bf16 v[40:43], v[96:99], v[132:135], v[40:43]
    v_mfma_f32_16x16x32_bf16 v[44:47], v[100:103], v[132:135], v[44:47]
    s_waitcnt lgkmcnt(5)
    v_mfma_f32_16x16x32_bf16 v[48:51], v[136:139], v[96:99], v[48:51]
    v_mfma_f32_16x16x32_bf16 v[52:55], v[136:139], v[100:103], v[52:55]
    ds_read_b128 v[120:123], v5 offset:30720
    ds_read_b128 v[124:127], v5 offset:31744
    ds_read_b128 v[128:131], v5 offset:32768
    ds_read_b128 v[132:135], v5 offset:33792
    ds_read_b128 v[136:139], v5 offset:34816
    s_waitcnt lgkmcnt(9)
    v_mfma_f32_16x16x32_bf16 v[56:59], v[140:143], v[96:99], v[56:59]
    v_mfma_f32_16x16x32_bf16 v[60:63], v[140:143], v[100:103], v[60:63]
    s_waitcnt lgkmcnt(8)
    v_mfma_f32_16x16x32_bf16 v[64:67], v[144:147], v[96:99], v[64:67]
    v_mfma_f32_16x16x32_bf16 v[68:71], v[144:147], v[100:103], v[68:71]
    s_waitcnt lgkmcnt(7)
    v_mfma_f32_16x16x32_bf16 v[72:75], v[148:151], v[96:99], v[72:75]
    v_mfma_f32_16x16x32_bf16 v[76:79], v[148:151], v[100:103], v[76:79]
    s_waitcnt lgkmcnt(6)
    v_mfma_f32_16x16x32_bf16 v[80:83], v[152:155], v[96:99], v[80:83]
    v_mfma_f32_16x16x32_bf16 v[84:87], v[152:155], v[100:103], v[84:87]
    s_waitcnt lgkmcnt(5)
    v_mfma_f32_16x16x32_bf16 v[88:91], v[156:159], v[96:99], v[88:91]
    v_mfma_f32_16x16x32_bf16 v[92:95], v[156:159], v[100:103], v[92:95]
    buffer_load_dwordx4 v[96:99], v2, s[28:31], s53 offen offset:1024
    buffer_load_dwordx4 v[100:103], v3, s[28:31], s53 offen offset:1024
    ds_read_b128 v[140:143], v5 offset:35840
    ds_read_b128 v[144:147], v5 offset:36864
    ds_read_b128 v[148:151], v5 offset:37888
    ds_read_b128 v[152:155], v5 offset:38912
    ds_read_b128 v[156:159], v5 offset:39936
    s_waitcnt vmcnt(5)
    s_waitcnt lgkmcnt(9)
    v_mfma_f32_16x16x32_bf16 v[16:19], v[120:123], v[104:107], v[16:19]
    s_waitcnt vmcnt(4)
    v_mfma_f32_16x16x32_bf16 v[20:23], v[120:123], v[108:111], v[20:23]
    s_waitcnt lgkmcnt(8)
    v_mfma_f32_16x16x32_bf16 v[24:27], v[124:127], v[104:107], v[24:27]
    v_mfma_f32_16x16x32_bf16 v[28:31], v[124:127], v[108:111], v[28:31]
    s_waitcnt lgkmcnt(7)
    v_mfma_f32_16x16x32_bf16 v[32:35], v[104:107], v[128:131], v[32:35]
    v_mfma_f32_16x16x32_bf16 v[36:39], v[108:111], v[128:131], v[36:39]
    s_waitcnt lgkmcnt(6)
    v_mfma_f32_16x16x32_bf16 v[40:43], v[104:107], v[132:135], v[40:43]
    v_mfma_f32_16x16x32_bf16 v[44:47], v[108:111], v[132:135], v[44:47]
    s_waitcnt lgkmcnt(5)
    v_mfma_f32_16x16x32_bf16 v[48:51], v[136:139], v[104:107], v[48:51]
    v_mfma_f32_16x16x32_bf16 v[52:55], v[136:139], v[108:111], v[52:55]
    s_waitcnt lgkmcnt(4)
    v_mfma_f32_16x16x32_bf16 v[56:59], v[140:143], v[104:107], v[56:59]
    v_mfma_f32_16x16x32_bf16 v[60:63], v[140:143], v[108:111], v[60:63]
    s_waitcnt lgkmcnt(3)
    v_mfma_f32_16x16x32_bf16 v[64:67], v[144:147], v[104:107], v[64:67]
    v_mfma_f32_16x16x32_bf16 v[68:71], v[144:147], v[108:111], v[68:71]
    s_waitcnt lgkmcnt(2)
    v_mfma_f32_16x16x32_bf16 v[72:75], v[148:151], v[104:107], v[72:75]
    v_mfma_f32_16x16x32_bf16 v[76:79], v[148:151], v[108:111], v[76:79]
    s_waitcnt lgkmcnt(1)
    v_mfma_f32_16x16x32_bf16 v[80:83], v[152:155], v[104:107], v[80:83]
    v_mfma_f32_16x16x32_bf16 v[84:87], v[152:155], v[108:111], v[84:87]
    s_waitcnt lgkmcnt(0)
    v_mfma_f32_16x16x32_bf16 v[88:91], v[156:159], v[104:107], v[88:91]
    v_mfma_f32_16x16x32_bf16 v[92:95], v[156:159], v[108:111], v[92:95]
    s_barrier
    ds_read_b128 v[120:123], v4 offset:0
    ds_read_b128 v[124:127], v4 offset:1024
    ds_read_b128 v[128:131], v4 offset:2048
    ds_read_b128 v[132:135], v4 offset:3072
    ds_read_b128 v[136:139], v4 offset:4096
    s_add_u32 m0, s51, 40960
    s_add_u32 s55, s46, 12288
    buffer_load_dwordx4 v1, s[28:31], s55 offen lds
    s_add_u32 m0, s51, 41984
    s_add_u32 s55, s47, 12288
    buffer_load_dwordx4 v1, s[28:31], s55 offen lds
    s_add_u32 m0, s51, 43008
    s_add_u32 s55, s48, 12288
    buffer_load_dwordx4 v1, s[28:31], s55 offen lds
    s_add_u32 m0, s51, 44032
    s_add_u32 s55, s49, 12288
    buffer_load_dwordx4 v1, s[28:31], s55 offen lds
    s_add_u32 m0, s51, 45056
    s_add_u32 s55, s50, 12288
    buffer_load_dwordx4 v1, s[28:31], s55 offen lds
    buffer_load_dwordx4 v[104:107], v2, s[28:31], s53 offen offset:2048
    buffer_load_dwordx4 v[108:111], v3, s[28:31], s53 offen offset:2048
    ds_read_b128 v[140:143], v4 offset:5120
    ds_read_b128 v[144:147], v4 offset:6144
    ds_read_b128 v[148:151], v4 offset:7168
    ds_read_b128 v[152:155], v4 offset:8192
    ds_read_b128 v[156:159], v4 offset:9216
    s_waitcnt vmcnt(10)
    s_waitcnt lgkmcnt(9)
    v_mfma_f32_16x16x32_bf16 v[16:19], v[120:123], v[112:115], v[16:19]
    s_waitcnt vmcnt(9)
    v_mfma_f32_16x16x32_bf16 v[20:23], v[120:123], v[116:119], v[20:23]
    s_waitcnt lgkmcnt(8)
    v_mfma_f32_16x16x32_bf16 v[24:27], v[124:127], v[112:115], v[24:27]
    v_mfma_f32_16x16x32_bf16 v[28:31], v[124:127], v[116:119], v[28:31]
    s_waitcnt lgkmcnt(7)
    v_mfma_f32_16x16x32_bf16 v[32:35], v[112:115], v[128:131], v[32:35]
    v_mfma_f32_16x16x32_bf16 v[36:39], v[116:119], v[128:131], v[36:39]
    s_waitcnt lgkmcnt(6)
    v_mfma_f32_16x16x32_bf16 v[40:43], v[112:115], v[132:135], v[40:43]
    v_mfma_f32_16x16x32_bf16 v[44:47], v[116:119], v[132:135], v[44:47]
    s_waitcnt lgkmcnt(5)
    v_mfma_f32_16x16x32_bf16 v[48:51], v[136:139], v[112:115], v[48:51]
    v_mfma_f32_16x16x32_bf16 v[52:55], v[136:139], v[116:119], v[52:55]
    ds_read_b128 v[120:123], v4 offset:10240
    ds_read_b128 v[124:127], v4 offset:11264
    ds_read_b128 v[128:131], v4 offset:12288
    ds_read_b128 v[132:135], v4 offset:13312
    ds_read_b128 v[136:139], v4 offset:14336
    s_waitcnt lgkmcnt(9)
    v_mfma_f32_16x16x32_bf16 v[56:59], v[140:143], v[112:115], v[56:59]
    v_mfma_f32_16x16x32_bf16 v[60:63], v[140:143], v[116:119], v[60:63]
    s_waitcnt lgkmcnt(8)
    v_mfma_f32_16x16x32_bf16 v[64:67], v[144:147], v[112:115], v[64:67]
    v_mfma_f32_16x16x32_bf16 v[68:71], v[144:147], v[116:119], v[68:71]
    s_waitcnt lgkmcnt(7)
    v_mfma_f32_16x16x32_bf16 v[72:75], v[148:151], v[112:115], v[72:75]
    v_mfma_f32_16x16x32_bf16 v[76:79], v[148:151], v[116:119], v[76:79]
    s_waitcnt lgkmcnt(6)
    v_mfma_f32_16x16x32_bf16 v[80:83], v[152:155], v[112:115], v[80:83]
    v_mfma_f32_16x16x32_bf16 v[84:87], v[152:155], v[116:119], v[84:87]
    s_waitcnt lgkmcnt(5)
    v_mfma_f32_16x16x32_bf16 v[88:91], v[156:159], v[112:115], v[88:91]
    v_mfma_f32_16x16x32_bf16 v[92:95], v[156:159], v[116:119], v[92:95]
    buffer_load_dwordx4 v[112:115], v2, s[28:31], s53 offen offset:3072
    buffer_load_dwordx4 v[116:119], v3, s[28:31], s53 offen offset:3072
    ds_read_b128 v[140:143], v4 offset:15360
    ds_read_b128 v[144:147], v4 offset:16384
    ds_read_b128 v[148:151], v4 offset:17408
    ds_read_b128 v[152:155], v4 offset:18432
    ds_read_b128 v[156:159], v4 offset:19456
    s_waitcnt vmcnt(10)
    s_waitcnt lgkmcnt(9)
    v_mfma_f32_16x16x32_bf16 v[16:19], v[120:123], v[96:99], v[16:19]
    s_waitcnt vmcnt(9)
    v_mfma_f32_16x16x32_bf16 v[20:23], v[120:123], v[100:103], v[20:23]
    s_waitcnt lgkmcnt(8)
    v_mfma_f32_16x16x32_bf16 v[24:27], v[124:127], v[96:99], v[24:27]
    v_mfma_f32_16x16x32_bf16 v[28:31], v[124:127], v[100:103], v[28:31]
    s_waitcnt lgkmcnt(7)
    v_mfma_f32_16x16x32_bf16 v[32:35], v[96:99], v[128:131], v[32:35]
    v_mfma_f32_16x16x32_bf16 v[36:39], v[100:103], v[128:131], v[36:39]
    s_waitcnt lgkmcnt(6)
    v_mfma_f32_16x16x32_bf16 v[40:43], v[96:99], v[132:135], v[40:43]
    v_mfma_f32_16x16x32_bf16 v[44:47], v[100:103], v[132:135], v[44:47]
    s_waitcnt lgkmcnt(5)
    v_mfma_f32_16x16x32_bf16 v[48:51], v[136:139], v[96:99], v[48:51]
    v_mfma_f32_16x16x32_bf16 v[52:55], v[136:139], v[100:103], v[52:55]
    ds_read_b128 v[120:123], v4 offset:20480
    ds_read_b128 v[124:127], v4 offset:21504
    ds_read_b128 v[128:131], v4 offset:22528
    ds_read_b128 v[132:135], v4 offset:23552
    ds_read_b128 v[136:139], v4 offset:24576
    s_waitcnt lgkmcnt(9)
    v_mfma_f32_16x16x32_bf16 v[56:59], v[140:143], v[96:99], v[56:59]
    v_mfma_f32_16x16x32_bf16 v[60:63], v[140:143], v[100:103], v[60:63]
    s_waitcnt lgkmcnt(8)
    v_mfma_f32_16x16x32_bf16 v[64:67], v[144:147], v[96:99], v[64:67]
    v_mfma_f32_16x16x32_bf16 v[68:71], v[144:147], v[100:103], v[68:71]
    s_waitcnt lgkmcnt(7)
    v_mfma_f32_16x16x32_bf16 v[72:75], v[148:151], v[96:99], v[72:75]
    v_mfma_f32_16x16x32_bf16 v[76:79], v[148:151], v[100:103], v[76:79]
    s_waitcnt lgkmcnt(6)
    v_mfma_f32_16x16x32_bf16 v[80:83], v[152:155], v[96:99], v[80:83]
    v_mfma_f32_16x16x32_bf16 v[84:87], v[152:155], v[100:103], v[84:87]
    s_waitcnt lgkmcnt(5)
    v_mfma_f32_16x16x32_bf16 v[88:91], v[156:159], v[96:99], v[88:91]
    v_mfma_f32_16x16x32_bf16 v[92:95], v[156:159], v[100:103], v[92:95]
    buffer_load_dwordx4 v[96:99], v2, s[28:31], s54 offen offset:0
    buffer_load_dwordx4 v[100:103], v3, s[28:31], s54 offen offset:0
    ds_read_b128 v[140:143], v4 offset:25600
    ds_read_b128 v[144:147], v4 offset:26624
    ds_read_b128 v[148:151], v4 offset:27648
    ds_read_b128 v[152:155], v4 offset:28672
    ds_read_b128 v[156:159], v4 offset:29696
    s_waitcnt vmcnt(5)
    s_waitcnt lgkmcnt(9)
    v_mfma_f32_16x16x32_bf16 v[16:19], v[120:123], v[104:107], v[16:19]
    s_waitcnt vmcnt(4)
    v_mfma_f32_16x16x32_bf16 v[20:23], v[120:123], v[108:111], v[20:23]
    s_waitcnt lgkmcnt(8)
    v_mfma_f32_16x16x32_bf16 v[24:27], v[124:127], v[104:107], v[24:27]
    v_mfma_f32_16x16x32_bf16 v[28:31], v[124:127], v[108:111], v[28:31]
    s_waitcnt lgkmcnt(7)
    v_mfma_f32_16x16x32_bf16 v[32:35], v[104:107], v[128:131], v[32:35]
    v_mfma_f32_16x16x32_bf16 v[36:39], v[108:111], v[128:131], v[36:39]
    s_waitcnt lgkmcnt(6)
    v_mfma_f32_16x16x32_bf16 v[40:43], v[104:107], v[132:135], v[40:43]
    v_mfma_f32_16x16x32_bf16 v[44:47], v[108:111], v[132:135], v[44:47]
    s_waitcnt lgkmcnt(5)
    v_mfma_f32_16x16x32_bf16 v[48:51], v[136:139], v[104:107], v[48:51]
    v_mfma_f32_16x16x32_bf16 v[52:55], v[136:139], v[108:111], v[52:55]
    ds_read_b128 v[120:123], v4 offset:30720
    ds_read_b128 v[124:127], v4 offset:31744
    ds_read_b128 v[128:131], v4 offset:32768
    ds_read_b128 v[132:135], v4 offset:33792
    ds_read_b128 v[136:139], v4 offset:34816
    s_waitcnt lgkmcnt(9)
    v_mfma_f32_16x16x32_bf16 v[56:59], v[140:143], v[104:107], v[56:59]
    v_mfma_f32_16x16x32_bf16 v[60:63], v[140:143], v[108:111], v[60:63]
    s_waitcnt lgkmcnt(8)
    v_mfma_f32_16x16x32_bf16 v[64:67], v[144:147], v[104:107], v[64:67]
    v_mfma_f32_16x16x32_bf16 v[68:71], v[144:147], v[108:111], v[68:71]
    s_waitcnt lgkmcnt(7)
    v_mfma_f32_16x16x32_bf16 v[72:75], v[148:151], v[104:107], v[72:75]
    v_mfma_f32_16x16x32_bf16 v[76:79], v[148:151], v[108:111], v[76:79]
    s_waitcnt lgkmcnt(6)
    v_mfma_f32_16x16x32_bf16 v[80:83], v[152:155], v[104:107], v[80:83]
    v_mfma_f32_16x16x32_bf16 v[84:87], v[152:155], v[108:111], v[84:87]
    s_waitcnt lgkmcnt(5)
    v_mfma_f32_16x16x32_bf16 v[88:91], v[156:159], v[104:107], v[88:91]
    v_mfma_f32_16x16x32_bf16 v[92:95], v[156:159], v[108:111], v[92:95]
    buffer_load_dwordx4 v[104:107], v2, s[28:31], s54 offen offset:1024
    buffer_load_dwordx4 v[108:111], v3, s[28:31], s54 offen offset:1024
    ds_read_b128 v[140:143], v4 offset:35840
    ds_read_b128 v[144:147], v4 offset:36864
    ds_read_b128 v[148:151], v4 offset:37888
    ds_read_b128 v[152:155], v4 offset:38912
    ds_read_b128 v[156:159], v4 offset:39936
    s_waitcnt vmcnt(5)
    s_waitcnt lgkmcnt(9)
    v_mfma_f32_16x16x32_bf16 v[16:19], v[120:123], v[112:115], v[16:19]
    s_waitcnt vmcnt(4)
    v_mfma_f32_16x16x32_bf16 v[20:23], v[120:123], v[116:119], v[20:23]
    s_waitcnt lgkmcnt(8)
    v_mfma_f32_16x16x32_bf16 v[24:27], v[124:127], v[112:115], v[24:27]
    v_mfma_f32_16x16x32_bf16 v[28:31], v[124:127], v[116:119], v[28:31]
    s_waitcnt lgkmcnt(7)
    v_mfma_f32_16x16x32_bf16 v[32:35], v[112:115], v[128:131], v[32:35]
    v_mfma_f32_16x16x32_bf16 v[36:39], v[116:119], v[128:131], v[36:39]
    s_waitcnt lgkmcnt(6)
    v_mfma_f32_16x16x32_bf16 v[40:43], v[112:115], v[132:135], v[40:43]
    v_mfma_f32_16x16x32_bf16 v[44:47], v[116:119], v[132:135], v[44:47]
    s_waitcnt lgkmcnt(5)
    v_mfma_f32_16x16x32_bf16 v[48:51], v[136:139], v[112:115], v[48:51]
    v_mfma_f32_16x16x32_bf16 v[52:55], v[136:139], v[116:119], v[52:55]
    s_waitcnt lgkmcnt(4)
    v_mfma_f32_16x16x32_bf16 v[56:59], v[140:143], v[112:115], v[56:59]
    v_mfma_f32_16x16x32_bf16 v[60:63], v[140:143], v[116:119], v[60:63]
    s_waitcnt lgkmcnt(3)
    v_mfma_f32_16x16x32_bf16 v[64:67], v[144:147], v[112:115], v[64:67]
    v_mfma_f32_16x16x32_bf16 v[68:71], v[144:147], v[116:119], v[68:71]
    s_waitcnt lgkmcnt(2)
    v_mfma_f32_16x16x32_bf16 v[72:75], v[148:151], v[112:115], v[72:75]
    v_mfma_f32_16x16x32_bf16 v[76:79], v[148:151], v[116:119], v[76:79]
    s_waitcnt lgkmcnt(1)
    v_mfma_f32_16x16x32_bf16 v[80:83], v[152:155], v[112:115], v[80:83]
    v_mfma_f32_16x16x32_bf16 v[84:87], v[152:155], v[116:119], v[84:87]
    s_waitcnt lgkmcnt(0)
    v_mfma_f32_16x16x32_bf16 v[88:91], v[156:159], v[112:115], v[88:91]
    v_mfma_f32_16x16x32_bf16 v[92:95], v[156:159], v[116:119], v[92:95]
    s_barrier
    ds_read_b128 v[120:123], v5 offset:0
    ds_read_b128 v[124:127], v5 offset:1024
    ds_read_b128 v[128:131], v5 offset:2048
    ds_read_b128 v[132:135], v5 offset:3072
    ds_read_b128 v[136:139], v5 offset:4096
    buffer_load_dwordx4 v[112:115], v2, s[28:31], s54 offen offset:2048
    buffer_load_dwordx4 v[116:119], v3, s[28:31], s54 offen offset:2048
    ds_read_b128 v[140:143], v5 offset:5120
    ds_read_b128 v[144:147], v5 offset:6144
    ds_read_b128 v[148:151], v5 offset:7168
    ds_read_b128 v[152:155], v5 offset:8192
    ds_read_b128 v[156:159], v5 offset:9216
    s_waitcnt vmcnt(5)
    s_waitcnt lgkmcnt(9)
    v_mfma_f32_16x16x32_bf16 v[16:19], v[120:123], v[96:99], v[16:19]
    s_waitcnt vmcnt(4)
    v_mfma_f32_16x16x32_bf16 v[20:23], v[120:123], v[100:103], v[20:23]
    s_waitcnt lgkmcnt(8)
    v_mfma_f32_16x16x32_bf16 v[24:27], v[124:127], v[96:99], v[24:27]
    v_mfma_f32_16x16x32_bf16 v[28:31], v[124:127], v[100:103], v[28:31]
    s_waitcnt lgkmcnt(7)
    v_mfma_f32_16x16x32_bf16 v[32:35], v[96:99], v[128:131], v[32:35]
    v_mfma_f32_16x16x32_bf16 v[36:39], v[100:103], v[128:131], v[36:39]
    s_waitcnt lgkmcnt(6)
    v_mfma_f32_16x16x32_bf16 v[40:43], v[96:99], v[132:135], v[40:43]
    v_mfma_f32_16x16x32_bf16 v[44:47], v[100:103], v[132:135], v[44:47]
    s_waitcnt lgkmcnt(5)
    v_mfma_f32_16x16x32_bf16 v[48:51], v[136:139], v[96:99], v[48:51]
    v_mfma_f32_16x16x32_bf16 v[52:55], v[136:139], v[100:103], v[52:55]
    ds_read_b128 v[120:123], v5 offset:10240
    ds_read_b128 v[124:127], v5 offset:11264
    ds_read_b128 v[128:131], v5 offset:12288
    ds_read_b128 v[132:135], v5 offset:13312
    ds_read_b128 v[136:139], v5 offset:14336
    s_waitcnt lgkmcnt(9)
    v_mfma_f32_16x16x32_bf16 v[56:59], v[140:143], v[96:99], v[56:59]
    v_mfma_f32_16x16x32_bf16 v[60:63], v[140:143], v[100:103], v[60:63]
    s_waitcnt lgkmcnt(8)
    v_mfma_f32_16x16x32_bf16 v[64:67], v[144:147], v[96:99], v[64:67]
    v_mfma_f32_16x16x32_bf16 v[68:71], v[144:147], v[100:103], v[68:71]
    s_waitcnt lgkmcnt(7)
    v_mfma_f32_16x16x32_bf16 v[72:75], v[148:151], v[96:99], v[72:75]
    v_mfma_f32_16x16x32_bf16 v[76:79], v[148:151], v[100:103], v[76:79]
    s_waitcnt lgkmcnt(6)
    v_mfma_f32_16x16x32_bf16 v[80:83], v[152:155], v[96:99], v[80:83]
    v_mfma_f32_16x16x32_bf16 v[84:87], v[152:155], v[100:103], v[84:87]
    s_waitcnt lgkmcnt(5)
    v_mfma_f32_16x16x32_bf16 v[88:91], v[156:159], v[96:99], v[88:91]
    v_mfma_f32_16x16x32_bf16 v[92:95], v[156:159], v[100:103], v[92:95]
    buffer_load_dwordx4 v[96:99], v2, s[28:31], s54 offen offset:3072
    buffer_load_dwordx4 v[100:103], v3, s[28:31], s54 offen offset:3072
    ds_read_b128 v[140:143], v5 offset:15360
    ds_read_b128 v[144:147], v5 offset:16384
    ds_read_b128 v[148:151], v5 offset:17408
    ds_read_b128 v[152:155], v5 offset:18432
    ds_read_b128 v[156:159], v5 offset:19456
    s_waitcnt vmcnt(5)
    s_waitcnt lgkmcnt(9)
    v_mfma_f32_16x16x32_bf16 v[16:19], v[120:123], v[104:107], v[16:19]
    s_waitcnt vmcnt(4)
    v_mfma_f32_16x16x32_bf16 v[20:23], v[120:123], v[108:111], v[20:23]
    s_waitcnt lgkmcnt(8)
    v_mfma_f32_16x16x32_bf16 v[24:27], v[124:127], v[104:107], v[24:27]
    v_mfma_f32_16x16x32_bf16 v[28:31], v[124:127], v[108:111], v[28:31]
    s_waitcnt lgkmcnt(7)
    v_mfma_f32_16x16x32_bf16 v[32:35], v[104:107], v[128:131], v[32:35]
    v_mfma_f32_16x16x32_bf16 v[36:39], v[108:111], v[128:131], v[36:39]
    s_waitcnt lgkmcnt(6)
    v_mfma_f32_16x16x32_bf16 v[40:43], v[104:107], v[132:135], v[40:43]
    v_mfma_f32_16x16x32_bf16 v[44:47], v[108:111], v[132:135], v[44:47]
    s_waitcnt lgkmcnt(5)
    v_mfma_f32_16x16x32_bf16 v[48:51], v[136:139], v[104:107], v[48:51]
    v_mfma_f32_16x16x32_bf16 v[52:55], v[136:139], v[108:111], v[52:55]
    ds_read_b128 v[120:123], v5 offset:20480
    ds_read_b128 v[124:127], v5 offset:21504
    ds_read_b128 v[128:131], v5 offset:22528
    ds_read_b128 v[132:135], v5 offset:23552
    ds_read_b128 v[136:139], v5 offset:24576
    s_waitcnt lgkmcnt(9)
    v_mfma_f32_16x16x32_bf16 v[56:59], v[140:143], v[104:107], v[56:59]
    v_mfma_f32_16x16x32_bf16 v[60:63], v[140:143], v[108:111], v[60:63]
    s_waitcnt lgkmcnt(8)
    v_mfma_f32_16x16x32_bf16 v[64:67], v[144:147], v[104:107], v[64:67]
    v_mfma_f32_16x16x32_bf16 v[68:71], v[144:147], v[108:111], v[68:71]
    s_waitcnt lgkmcnt(7)
    v_mfma_f32_16x16x32_bf16 v[72:75], v[148:151], v[104:107], v[72:75]
    v_mfma_f32_16x16x32_bf16 v[76:79], v[148:151], v[108:111], v[76:79]
    s_waitcnt lgkmcnt(6)
    v_mfma_f32_16x16x32_bf16 v[80:83], v[152:155], v[104:107], v[80:83]
    v_mfma_f32_16x16x32_bf16 v[84:87], v[152:155], v[108:111], v[84:87]
    s_waitcnt lgkmcnt(5)
    v_mfma_f32_16x16x32_bf16 v[88:91], v[156:159], v[104:107], v[88:91]
    v_mfma_f32_16x16x32_bf16 v[92:95], v[156:159], v[108:111], v[92:95]
    ds_read_b128 v[140:143], v5 offset:25600
    ds_read_b128 v[144:147], v5 offset:26624
    ds_read_b128 v[148:151], v5 offset:27648
    ds_read_b128 v[152:155], v5 offset:28672
    ds_read_b128 v[156:159], v5 offset:29696
    s_waitcnt vmcnt(3)
    s_waitcnt lgkmcnt(9)
    v_mfma_f32_16x16x32_bf16 v[16:19], v[120:123], v[112:115], v[16:19]
    s_waitcnt vmcnt(2)
    v_mfma_f32_16x16x32_bf16 v[20:23], v[120:123], v[116:119], v[20:23]
    s_waitcnt lgkmcnt(8)
    v_mfma_f32_16x16x32_bf16 v[24:27], v[124:127], v[112:115], v[24:27]
    v_mfma_f32_16x16x32_bf16 v[28:31], v[124:127], v[116:119], v[28:31]
    s_waitcnt lgkmcnt(7)
    v_mfma_f32_16x16x32_bf16 v[32:35], v[112:115], v[128:131], v[32:35]
    v_mfma_f32_16x16x32_bf16 v[36:39], v[116:119], v[128:131], v[36:39]
    s_waitcnt lgkmcnt(6)
    v_mfma_f32_16x16x32_bf16 v[40:43], v[112:115], v[132:135], v[40:43]
    v_mfma_f32_16x16x32_bf16 v[44:47], v[116:119], v[132:135], v[44:47]
    s_waitcnt lgkmcnt(5)
    v_mfma_f32_16x16x32_bf16 v[48:51], v[136:139], v[112:115], v[48:51]
    v_mfma_f32_16x16x32_bf16 v[52:55], v[136:139], v[116:119], v[52:55]
    ds_read_b128 v[120:123], v5 offset:30720
    ds_read_b128 v[124:127], v5 offset:31744
    ds_read_b128 v[128:131], v5 offset:32768
    ds_read_b128 v[132:135], v5 offset:33792
    ds_read_b128 v[136:139], v5 offset:34816
    s_waitcnt lgkmcnt(9)
    v_mfma_f32_16x16x32_bf16 v[56:59], v[140:143], v[112:115], v[56:59]
    v_mfma_f32_16x16x32_bf16 v[60:63], v[140:143], v[116:119], v[60:63]
    s_waitcnt lgkmcnt(8)
    v_mfma_f32_16x16x32_bf16 v[64:67], v[144:147], v[112:115], v[64:67]
    v_mfma_f32_16x16x32_bf16 v[68:71], v[144:147], v[116:119], v[68:71]
    s_waitcnt lgkmcnt(7)
    v_mfma_f32_16x16x32_bf16 v[72:75], v[148:151], v[112:115], v[72:75]
    v_mfma_f32_16x16x32_bf16 v[76:79], v[148:151], v[116:119], v[76:79]
    s_waitcnt lgkmcnt(6)
    v_mfma_f32_16x16x32_bf16 v[80:83], v[152:155], v[112:115], v[80:83]
    v_mfma_f32_16x16x32_bf16 v[84:87], v[152:155], v[116:119], v[84:87]
    s_waitcnt lgkmcnt(5)
    v_mfma_f32_16x16x32_bf16 v[88:91], v[156:159], v[112:115], v[88:91]
    v_mfma_f32_16x16x32_bf16 v[92:95], v[156:159], v[116:119], v[92:95]
    ds_read_b128 v[140:143], v5 offset:35840
    ds_read_b128 v[144:147], v5 offset:36864
    ds_read_b128 v[148:151], v5 offset:37888
    ds_read_b128 v[152:155], v5 offset:38912
    ds_read_b128 v[156:159], v5 offset:39936
    s_waitcnt vmcnt(1)
    s_waitcnt lgkmcnt(9)
    v_mfma_f32_16x16x32_bf16 v[16:19], v[120:123], v[96:99], v[16:19]
    s_waitcnt vmcnt(0)
    v_mfma_f32_16x16x32_bf16 v[20:23], v[120:123], v[100:103], v[20:23]
    s_waitcnt lgkmcnt(8)
    v_mfma_f32_16x16x32_bf16 v[24:27], v[124:127], v[96:99], v[24:27]
    v_mfma_f32_16x16x32_bf16 v[28:31], v[124:127], v[100:103], v[28:31]
    s_waitcnt lgkmcnt(7)
    v_mfma_f32_16x16x32_bf16 v[32:35], v[96:99], v[128:131], v[32:35]
    v_mfma_f32_16x16x32_bf16 v[36:39], v[100:103], v[128:131], v[36:39]
    s_waitcnt lgkmcnt(6)
    v_mfma_f32_16x16x32_bf16 v[40:43], v[96:99], v[132:135], v[40:43]
    v_mfma_f32_16x16x32_bf16 v[44:47], v[100:103], v[132:135], v[44:47]
    s_waitcnt lgkmcnt(5)
    v_mfma_f32_16x16x32_bf16 v[48:51], v[136:139], v[96:99], v[48:51]
    v_mfma_f32_16x16x32_bf16 v[52:55], v[136:139], v[100:103], v[52:55]
    s_waitcnt lgkmcnt(4)
    v_mfma_f32_16x16x32_bf16 v[56:59], v[140:143], v[96:99], v[56:59]
    v_mfma_f32_16x16x32_bf16 v[60:63], v[140:143], v[100:103], v[60:63]
    s_waitcnt lgkmcnt(3)
    v_mfma_f32_16x16x32_bf16 v[64:67], v[144:147], v[96:99], v[64:67]
    v_mfma_f32_16x16x32_bf16 v[68:71], v[144:147], v[100:103], v[68:71]
    s_waitcnt lgkmcnt(2)
    v_mfma_f32_16x16x32_bf16 v[72:75], v[148:151], v[96:99], v[72:75]
    v_mfma_f32_16x16x32_bf16 v[76:79], v[148:151], v[100:103], v[76:79]
    s_waitcnt lgkmcnt(1)
    v_mfma_f32_16x16x32_bf16 v[80:83], v[152:155], v[96:99], v[80:83]
    v_mfma_f32_16x16x32_bf16 v[84:87], v[152:155], v[100:103], v[84:87]
    s_waitcnt lgkmcnt(0)
    v_mfma_f32_16x16x32_bf16 v[88:91], v[156:159], v[96:99], v[88:91]
    v_mfma_f32_16x16x32_bf16 v[92:95], v[156:159], v[100:103], v[92:95]
    v_and_b32 v11, 63, v0
    v_lshlrev_b32 v7, 3, v11
    v_lshlrev_b32 v8, 2, v11
    v_lshrrev_b32 v160, 5, v11
    v_lshlrev_b32 v160, 8, v160
    v_and_b32 v161, 15, v11
    v_lshl_add_u32 v160, v161, 4, v160
    v_bfe_u32 v161, v11, 4, 1
    v_lshl_add_u32 v6, v161, 3, v160
    v_mov_b32 v204, 0xc0135761
    v_mov_b32 v205, 0xbdd2d3e8
    s_mul_i32 s61, s33, 1536
    s_add_u32 s61, s61, s58
    s_mul_i32 s62, s33, 1024
    s_add_u32 s62, s62, s59
    v_mov_b32 v12, 0x3f803f80
    v_mov_b32 v13, 0x3f803f80
    v_mov_b32 v14, 0x3f803f80
    v_mov_b32 v15, 0x3f803f80
    s_lshl_b32 s55, s34, 10
    s_add_u32 s55, s55, 81920
    v_add_u32 v9, s55, v1
    v_cvt_pk_bf16_f32 v168, v32, v33
    v_cvt_pk_bf16_f32 v169, v34, v35
    v_lshlrev_b32 v160, 16, v168
    v_and_b32 v161, 0xffff0000, v168
    v_lshlrev_b32 v162, 16, v169
    v_and_b32 v163, 0xffff0000, v169
    v_mul_f32 v174, 0x3fb8aa3b, v160
    v_mul_f32 v175, 0x3fb8aa3b, v161
    v_mul_f32 v176, 0x3fb8aa3b, v162
    v_mul_f32 v177, 0x3fb8aa3b, v163
    v_exp_f32 v174, v174
    v_exp_f32 v175, v175
    v_exp_f32 v176, v176
    v_exp_f32 v177, v177
    v_add_f32 v170, 1.0, v160
    v_add_f32 v171, 1.0, v161
    v_add_f32 v172, 1.0, v162
    v_add_f32 v173, 1.0, v163
    v_cmp_lt_f32 s[64:65], 0, v160
    v_cmp_lt_f32 s[66:67], 0, v161
    v_cmp_lt_f32 s[68:69], 0, v162
    v_cmp_lt_f32 s[70:71], 0, v163
    v_cvt_pk_bf16_f32 v178, v170, v174
    v_cvt_pk_bf16_f32 v179, v171, v175
    v_cvt_pk_bf16_f32 v180, v172, v176
    v_cvt_pk_bf16_f32 v181, v173, v177
    v_lshlrev_b32 v170, 16, v178
    v_lshlrev_b32 v171, 16, v179
    v_lshlrev_b32 v172, 16, v180
    v_lshlrev_b32 v173, 16, v181
    v_and_b32 v174, 0xffff0000, v178
    v_and_b32 v175, 0xffff0000, v179
    v_and_b32 v176, 0xffff0000, v180
    v_and_b32 v177, 0xffff0000, v181
    v_add_f32 v174, 0x358637bd, v174
    v_add_f32 v175, 0x358637bd, v175
    v_add_f32 v176, 0x358637bd, v176
    v_add_f32 v177, 0x358637bd, v177
    v_cndmask_b32 v184, v174, v170, s[64:65]
    v_cndmask_b32 v185, v175, v171, s[66:67]
    v_cndmask_b32 v186, v176, v172, s[68:69]
    v_cndmask_b32 v187, v177, v173, s[70:71]
    v_cvt_pk_bf16_f32 v168, v36, v37
    v_cvt_pk_bf16_f32 v169, v38, v39
    v_lshlrev_b32 v160, 16, v168
    v_and_b32 v161, 0xffff0000, v168
    v_lshlrev_b32 v162, 16, v169
    v_and_b32 v163, 0xffff0000, v169
    v_mul_f32 v174, 0x3fb8aa3b, v160
    v_mul_f32 v175, 0x3fb8aa3b, v161
    v_mul_f32 v176, 0x3fb8aa3b, v162
    v_mul_f32 v177, 0x3fb8aa3b, v163
    v_exp_f32 v174, v174
    v_exp_f32 v175, v175
    v_exp_f32 v176, v176
    v_exp_f32 v177, v177
    v_add_f32 v170, 1.0, v160
    v_add_f32 v171, 1.0, v161
    v_add_f32 v172, 1.0, v162
    v_add_f32 v173, 1.0, v163
    v_cmp_lt_f32 s[64:65], 0, v160
    v_cmp_lt_f32 s[66:67], 0, v161
    v_cmp_lt_f32 s[68:69], 0, v162
    v_cmp_lt_f32 s[70:71], 0, v163
    v_cvt_pk_bf16_f32 v178, v170, v174
    v_cvt_pk_bf16_f32 v179, v171, v175
    v_cvt_pk_bf16_f32 v180, v172, v176
    v_cvt_pk_bf16_f32 v181, v173, v177
    v_lshlrev_b32 v170, 16, v178
    v_lshlrev_b32 v171, 16, v179
    v_lshlrev_b32 v172, 16, v180
    v_lshlrev_b32 v173, 16, v181
    v_and_b32 v174, 0xffff0000, v178
    v_and_b32 v175, 0xffff0000, v179
    v_and_b32 v176, 0xffff0000, v180
    v_and_b32 v177, 0xffff0000, v181
    v_add_f32 v174, 0x358637bd, v174
    v_add_f32 v175, 0x358637bd, v175
    v_add_f32 v176, 0x358637bd, v176
    v_add_f32 v177, 0x358637bd, v177
    v_cndmask_b32 v188, v174, v170, s[64:65]
    v_cndmask_b32 v189, v175, v171, s[66:67]
    v_cndmask_b32 v190, v176, v172, s[68:69]
    v_cndmask_b32 v191, v177, v173, s[70:71]
    v_cvt_pk_bf16_f32 v192, v184, v185
    v_cvt_pk_bf16_f32 v193, v186, v187
    v_cvt_pk_bf16_f32 v194, v188, v189
    v_cvt_pk_bf16_f32 v195, v190, v191
    v_cvt_pk_bf16_f32 v196, v40, v41
    v_cvt_pk_bf16_f32 v197, v42, v43
    v_cvt_pk_bf16_f32 v198, v44, v45
    v_cvt_pk_bf16_f32 v199, v46, v47
    s_nop 1
    v_mfma_f32_16x16x32_bf16 v[120:123], v[192:195], v[196:199], 0
    v_mfma_f32_16x16x32_bf16 v[124:127], v[192:195], v[12:15], 0
    s_nop 6
    ds_write_b128 v9, v[120:123] offset:0
    ds_write_b128 v9, v[124:127] offset:8192
    v_cvt_pk_bf16_f32 v168, v16, v17
    v_cvt_pk_bf16_f32 v169, v18, v19
    v_lshlrev_b32 v160, 16, v168
    v_and_b32 v161, 0xffff0000, v168
    v_lshlrev_b32 v162, 16, v169
    v_and_b32 v163, 0xffff0000, v169
    v_mul_f32 v174, 0x3fb8aa3b, v160
    v_mul_f32 v175, 0x3fb8aa3b, v161
    v_mul_f32 v176, 0x3fb8aa3b, v162
    v_mul_f32 v177, 0x3fb8aa3b, v163
    v_exp_f32 v174, v174
    v_exp_f32 v175, v175
    v_exp_f32 v176, v176
    v_exp_f32 v177, v177
    v_add_f32 v170, 1.0, v160
    v_add_f32 v171, 1.0, v161
    v_add_f32 v172, 1.0, v162
    v_add_f32 v173, 1.0, v163
    v_cmp_lt_f32 s[64:65], 0, v160
    v_cmp_lt_f32 s[66:67], 0, v161
    v_cmp_lt_f32 s[68:69], 0, v162
    v_cmp_lt_f32 s[70:71], 0, v163
    v_cvt_pk_bf16_f32 v178, v170, v174
    v_cvt_pk_bf16_f32 v179, v171, v175
    v_cvt_pk_bf16_f32 v180, v172, v176
    v_cvt_pk_bf16_f32 v181, v173, v177
    v_lshlrev_b32 v170, 16, v178
    v_lshlrev_b32 v171, 16, v179
    v_lshlrev_b32 v172, 16, v180
    v_lshlrev_b32 v173, 16, v181
    v_and_b32 v174, 0xffff0000, v178
    v_and_b32 v175, 0xffff0000, v179
    v_and_b32 v176, 0xffff0000, v180
    v_and_b32 v177, 0xffff0000, v181
    v_add_f32 v174, 0x358637bd, v174
    v_add_f32 v175, 0x358637bd, v175
    v_add_f32 v176, 0x358637bd, v176
    v_add_f32 v177, 0x358637bd, v177
    v_cndmask_b32 v164, v174, v170, s[64:65]
    v_cndmask_b32 v165, v175, v171, s[66:67]
    v_cndmask_b32 v166, v176, v172, s[68:69]
    v_cndmask_b32 v167, v177, v173, s[70:71]
    v_cvt_pk_bf16_f32 v182, v164, v165
    v_cvt_pk_bf16_f32 v183, v166, v167
    s_add_u32 s55, s62, 0x0
    buffer_store_dwordx2 v[182:183], v7, s[28:31], s55 offen sc1
    v_cvt_pk_bf16_f32 v168, v20, v21
    v_cvt_pk_bf16_f32 v169, v22, v23
    v_lshlrev_b32 v160, 16, v168
    v_and_b32 v161, 0xffff0000, v168
    v_lshlrev_b32 v162, 16, v169
    v_and_b32 v163, 0xffff0000, v169
    v_mul_f32 v174, 0x3fb8aa3b, v160
    v_mul_f32 v175, 0x3fb8aa3b, v161
    v_mul_f32 v176, 0x3fb8aa3b, v162
    v_mul_f32 v177, 0x3fb8aa3b, v163
    v_exp_f32 v174, v174
    v_exp_f32 v175, v175
    v_exp_f32 v176, v176
    v_exp_f32 v177, v177
    v_add_f32 v170, 1.0, v160
    v_add_f32 v171, 1.0, v161
    v_add_f32 v172, 1.0, v162
    v_add_f32 v173, 1.0, v163
    v_cmp_lt_f32 s[64:65], 0, v160
    v_cmp_lt_f32 s[66:67], 0, v161
    v_cmp_lt_f32 s[68:69], 0, v162
    v_cmp_lt_f32 s[70:71], 0, v163
    v_cvt_pk_bf16_f32 v178, v170, v174
    v_cvt_pk_bf16_f32 v179, v171, v175
    v_cvt_pk_bf16_f32 v180, v172, v176
    v_cvt_pk_bf16_f32 v181, v173, v177
    v_lshlrev_b32 v170, 16, v178
    v_lshlrev_b32 v171, 16, v179
    v_lshlrev_b32 v172, 16, v180
    v_lshlrev_b32 v173, 16, v181
    v_and_b32 v174, 0xffff0000, v178
    v_and_b32 v175, 0xffff0000, v179
    v_and_b32 v176, 0xffff0000, v180
    v_and_b32 v177, 0xffff0000, v181
    v_add_f32 v174, 0x358637bd, v174
    v_add_f32 v175, 0x358637bd, v175
    v_add_f32 v176, 0x358637bd, v176
    v_add_f32 v177, 0x358637bd, v177
    v_cndmask_b32 v164, v174, v170, s[64:65]
    v_cndmask_b32 v165, v175, v171, s[66:67]
    v_cndmask_b32 v166, v176, v172, s[68:69]
    v_cndmask_b32 v167, v177, v173, s[70:71]
    v_cvt_pk_bf16_f32 v182, v164, v165
    v_cvt_pk_bf16_f32 v183, v166, v167
    s_add_u32 s55, s62, 0x4000
    buffer_store_dwordx2 v[182:183], v7, s[28:31], s55 offen sc1
    v_cvt_pk_bf16_f32 v168, v24, v25
    v_cvt_pk_bf16_f32 v169, v26, v27
    v_lshlrev_b32 v160, 16, v168
    v_and_b32 v161, 0xffff0000, v168
    v_lshlrev_b32 v162, 16, v169
    v_and_b32 v163, 0xffff0000, v169
    v_mul_f32 v174, 0x3fb8aa3b, v160
    v_mul_f32 v175, 0x3fb8aa3b, v161
    v_mul_f32 v176, 0x3fb8aa3b, v162
    v_mul_f32 v177, 0x3fb8aa3b, v163
    v_exp_f32 v174, v174
    v_exp_f32 v175, v175
    v_exp_f32 v176, v176
    v_exp_f32 v177, v177
    v_add_f32 v170, 1.0, v160
    v_add_f32 v171, 1.0, v161
    v_add_f32 v172, 1.0, v162
    v_add_f32 v173, 1.0, v163
    v_cmp_lt_f32 s[64:65], 0, v160
    v_cmp_lt_f32 s[66:67], 0, v161
    v_cmp_lt_f32 s[68:69], 0, v162
    v_cmp_lt_f32 s[70:71], 0, v163
    v_cvt_pk_bf16_f32 v178, v170, v174
    v_cvt_pk_bf16_f32 v179, v171, v175
    v_cvt_pk_bf16_f32 v180, v172, v176
    v_cvt_pk_bf16_f32 v181, v173, v177
    v_lshlrev_b32 v170, 16, v178
    v_lshlrev_b32 v171, 16, v179
    v_lshlrev_b32 v172, 16, v180
    v_lshlrev_b32 v173, 16, v181
    v_and_b32 v174, 0xffff0000, v178
    v_and_b32 v175, 0xffff0000, v179
    v_and_b32 v176, 0xffff0000, v180
    v_and_b32 v177, 0xffff0000, v181
    v_add_f32 v174, 0x358637bd, v174
    v_add_f32 v175, 0x358637bd, v175
    v_add_f32 v176, 0x358637bd, v176
    v_add_f32 v177, 0x358637bd, v177
    v_cndmask_b32 v164, v174, v170, s[64:65]
    v_cndmask_b32 v165, v175, v171, s[66:67]
    v_cndmask_b32 v166, v176, v172, s[68:69]
    v_cndmask_b32 v167, v177, v173, s[70:71]
    v_cvt_pk_bf16_f32 v182, v164, v165
    v_cvt_pk_bf16_f32 v183, v166, v167
    s_add_u32 s55, s62, 0x200
    buffer_store_dwordx2 v[182:183], v7, s[28:31], s55 offen sc1
    v_cvt_pk_bf16_f32 v168, v28, v29
    v_cvt_pk_bf16_f32 v169, v30, v31
    v_lshlrev_b32 v160, 16, v168
    v_and_b32 v161, 0xffff0000, v168
    v_lshlrev_b32 v162, 16, v169
    v_and_b32 v163, 0xffff0000, v169
    v_mul_f32 v174, 0x3fb8aa3b, v160
    v_mul_f32 v175, 0x3fb8aa3b, v161
    v_mul_f32 v176, 0x3fb8aa3b, v162
    v_mul_f32 v177, 0x3fb8aa3b, v163
    v_exp_f32 v174, v174
    v_exp_f32 v175, v175
    v_exp_f32 v176, v176
    v_exp_f32 v177, v177
    v_add_f32 v170, 1.0, v160
    v_add_f32 v171, 1.0, v161
    v_add_f32 v172, 1.0, v162
    v_add_f32 v173, 1.0, v163
    v_cmp_lt_f32 s[64:65], 0, v160
    v_cmp_lt_f32 s[66:67], 0, v161
    v_cmp_lt_f32 s[68:69], 0, v162
    v_cmp_lt_f32 s[70:71], 0, v163
    v_cvt_pk_bf16_f32 v178, v170, v174
    v_cvt_pk_bf16_f32 v179, v171, v175
    v_cvt_pk_bf16_f32 v180, v172, v176
    v_cvt_pk_bf16_f32 v181, v173, v177
    v_lshlrev_b32 v170, 16, v178
    v_lshlrev_b32 v171, 16, v179
    v_lshlrev_b32 v172, 16, v180
    v_lshlrev_b32 v173, 16, v181
    v_and_b32 v174, 0xffff0000, v178
    v_and_b32 v175, 0xffff0000, v179
    v_and_b32 v176, 0xffff0000, v180
    v_and_b32 v177, 0xffff0000, v181
    v_add_f32 v174, 0x358637bd, v174
    v_add_f32 v175, 0x358637bd, v175
    v_add_f32 v176, 0x358637bd, v176
    v_add_f32 v177, 0x358637bd, v177
    v_cndmask_b32 v164, v174, v170, s[64:65]
    v_cndmask_b32 v165, v175, v171, s[66:67]
    v_cndmask_b32 v166, v176, v172, s[68:69]
    v_cndmask_b32 v167, v177, v173, s[70:71]
    v_cvt_pk_bf16_f32 v182, v164, v165
    v_cvt_pk_bf16_f32 v183, v166, v167
    s_add_u32 s55, s62, 0x4200
    buffer_store_dwordx2 v[182:183], v7, s[28:31], s55 offen sc1
    v_cvt_pk_bf16_f32 v172, v48, v49
    v_cvt_pk_bf16_f32 v173, v50, v51
    v_lshlrev_b32 v160, 16, v172
    v_and_b32 v161, 0xffff0000, v172
    v_lshlrev_b32 v162, 16, v173
    v_and_b32 v163, 0xffff0000, v173
    v_mul_f32 v164, v160, v160
    v_mul_f32 v165, v161, v161
    v_mul_f32 v166, v162, v162
    v_mul_f32 v167, v163, v163
    v_fma_f32 v164, v164, v205, v204
    v_fma_f32 v165, v165, v205, v204
    v_fma_f32 v166, v166, v205, v204
    v_fma_f32 v167, v167, v205, v204
    v_mul_f32 v164, v160, v164
    v_mul_f32 v165, v161, v165
    v_mul_f32 v166, v162, v166
    v_mul_f32 v167, v163, v167
    v_exp_f32 v164, v164
    v_exp_f32 v165, v165
    v_exp_f32 v166, v166
    v_exp_f32 v167, v167
    v_add_f32 v164, 1.0, v164
    v_add_f32 v165, 1.0, v165
    v_add_f32 v166, 1.0, v166
    v_add_f32 v167, 1.0, v167
    v_rcp_f32 v164, v164
    v_rcp_f32 v165, v165
    v_rcp_f32 v166, v166
    v_rcp_f32 v167, v167
    v_mul_f32 v164, v160, v164
    v_mul_f32 v165, v161, v165
    v_mul_f32 v166, v162, v166
    v_mul_f32 v167, v163, v167
    v_cvt_pk_bf16_f32 v172, v164, v165
    v_cvt_pk_bf16_f32 v173, v166, v167
    v_lshlrev_b32 v164, 16, v172
    v_and_b32 v165, 0xffff0000, v172
    v_lshlrev_b32 v166, 16, v173
    v_and_b32 v167, 0xffff0000, v173
    v_cvt_pk_bf16_f32 v174, v56, v57
    v_cvt_pk_bf16_f32 v175, v58, v59
    v_lshlrev_b32 v168, 16, v174
    v_and_b32 v169, 0xffff0000, v174
    v_lshlrev_b32 v170, 16, v175
    v_and_b32 v171, 0xffff0000, v175
    v_mul_f32 v164, v164, v168
    v_mul_f32 v165, v165, v169
    v_mul_f32 v166, v166, v170
    v_mul_f32 v167, v167, v171
    v_cvt_pk_bf16_f32 v176, v164, v165
    v_cvt_pk_bf16_f32 v177, v166, v167
    s_add_u32 s55, s61, 0x0
    buffer_store_dwordx2 v[176:177], v6, s[28:31], s55 offen sc1
    v_cvt_pk_bf16_f32 v172, v52, v53
    v_cvt_pk_bf16_f32 v173, v54, v55
    v_lshlrev_b32 v160, 16, v172
    v_and_b32 v161, 0xffff0000, v172
    v_lshlrev_b32 v162, 16, v173
    v_and_b32 v163, 0xffff0000, v173
    v_mul_f32 v164, v160, v160
    v_mul_f32 v165, v161, v161
    v_mul_f32 v166, v162, v162
    v_mul_f32 v167, v163, v163
    v_fma_f32 v164, v164, v205, v204
    v_fma_f32 v165, v165, v205, v204
    v_fma_f32 v166, v166, v205, v204
    v_fma_f32 v167, v167, v205, v204
    v_mul_f32 v164, v160, v164
    v_mul_f32 v165, v161, v165
    v_mul_f32 v166, v162, v166
    v_mul_f32 v167, v163, v167
    v_exp_f32 v164, v164
    v_exp_f32 v165, v165
    v_exp_f32 v166, v166
    v_exp_f32 v167, v167
    v_add_f32 v164, 1.0, v164
    v_add_f32 v165, 1.0, v165
    v_add_f32 v166, 1.0, v166
    v_add_f32 v167, 1.0, v167
    v_rcp_f32 v164, v164
    v_rcp_f32 v165, v165
    v_rcp_f32 v166, v166
    v_rcp_f32 v167, v167
    v_mul_f32 v164, v160, v164
    v_mul_f32 v165, v161, v165
    v_mul_f32 v166, v162, v166
    v_mul_f32 v167, v163, v167
    v_cvt_pk_bf16_f32 v172, v164, v165
    v_cvt_pk_bf16_f32 v173, v166, v167
    v_lshlrev_b32 v164, 16, v172
    v_and_b32 v165, 0xffff0000, v172
    v_lshlrev_b32 v166, 16, v173
    v_and_b32 v167, 0xffff0000, v173
    v_cvt_pk_bf16_f32 v174, v60, v61
    v_cvt_pk_bf16_f32 v175, v62, v63
    v_lshlrev_b32 v168, 16, v174
    v_and_b32 v169, 0xffff0000, v174
    v_lshlrev_b32 v170, 16, v175
    v_and_b32 v171, 0xffff0000, v175
    v_mul_f32 v164, v164, v168
    v_mul_f32 v165, v165, v169
    v_mul_f32 v166, v166, v170
    v_mul_f32 v167, v167, v171
    v_cvt_pk_bf16_f32 v176, v164, v165
    v_cvt_pk_bf16_f32 v177, v166, v167
    s_add_u32 s55, s61, 0xe000
    buffer_store_dwordx2 v[176:177], v6, s[28:31], s55 offen sc1
    v_cvt_pk_bf16_f32 v172, v64, v65
    v_cvt_pk_bf16_f32 v173, v66, v67
    v_lshlrev_b32 v160, 16, v172
    v_and_b32 v161, 0xffff0000, v172
    v_lshlrev_b32 v162, 16, v173
    v_and_b32 v163, 0xffff0000, v173
    v_mul_f32 v164, v160, v160
    v_mul_f32 v165, v161, v161
    v_mul_f32 v166, v162, v162
    v_mul_f32 v167, v163, v163
    v_fma_f32 v164, v164, v205, v204
    v_fma_f32 v165, v165, v205, v204
    v_fma_f32 v166, v166, v205, v204
    v_fma_f32 v167, v167, v205, v204
    v_mul_f32 v164, v160, v164
    v_mul_f32 v165, v161, v165
    v_mul_f32 v166, v162, v166
    v_mul_f32 v167, v163, v167
    v_exp_f32 v164, v164
    v_exp_f32 v165, v165
    v_exp_f32 v166, v166
    v_exp_f32 v167, v167
    v_add_f32 v164, 1.0, v164
    v_add_f32 v165, 1.0, v165
    v_add_f32 v166, 1.0, v166
    v_add_f32 v167, 1.0, v167
    v_rcp_f32 v164, v164
    v_rcp_f32 v165, v165
    v_rcp_f32 v166, v166
    v_rcp_f32 v167, v167
    v_mul_f32 v164, v160, v164
    v_mul_f32 v165, v161, v165
    v_mul_f32 v166, v162, v166
    v_mul_f32 v167, v163, v167
    v_cvt_pk_bf16_f32 v172, v164, v165
    v_cvt_pk_bf16_f32 v173, v166, v167
    v_lshlrev_b32 v164, 16, v172
    v_and_b32 v165, 0xffff0000, v172
    v_lshlrev_b32 v166, 16, v173
    v_and_b32 v167, 0xffff0000, v173
    v_cvt_pk_bf16_f32 v174, v72, v73
    v_cvt_pk_bf16_f32 v175, v74, v75
    v_lshlrev_b32 v168, 16, v174
    v_and_b32 v169, 0xffff0000, v174
    v_lshlrev_b32 v170, 16, v175
    v_and_b32 v171, 0xffff0000, v175
    v_mul_f32 v164, v164, v168
    v_mul_f32 v165, v165, v169
    v_mul_f32 v166, v166, v170
    v_mul_f32 v167, v167, v171
    v_cvt_pk_bf16_f32 v176, v164, v165
    v_cvt_pk_bf16_f32 v177, v166, v167
    s_add_u32 s55, s61, 0x200
    buffer_store_dwordx2 v[176:177], v6, s[28:31], s55 offen sc1
    v_cvt_pk_bf16_f32 v172, v68, v69
    v_cvt_pk_bf16_f32 v173, v70, v71
    v_lshlrev_b32 v160, 16, v172
    v_and_b32 v161, 0xffff0000, v172
    v_lshlrev_b32 v162, 16, v173
    v_and_b32 v163, 0xffff0000, v173
    v_mul_f32 v164, v160, v160
    v_mul_f32 v165, v161, v161
    v_mul_f32 v166, v162, v162
    v_mul_f32 v167, v163, v163
    v_fma_f32 v164, v164, v205, v204
    v_fma_f32 v165, v165, v205, v204
    v_fma_f32 v166, v166, v205, v204
    v_fma_f32 v167, v167, v205, v204
    v_mul_f32 v164, v160, v164
    v_mul_f32 v165, v161, v165
    v_mul_f32 v166, v162, v166
    v_mul_f32 v167, v163, v167
    v_exp_f32 v164, v164
    v_exp_f32 v165, v165
    v_exp_f32 v166, v166
    v_exp_f32 v167, v167
    v_add_f32 v164, 1.0, v164
    v_add_f32 v165, 1.0, v165
    v_add_f32 v166, 1.0, v166
    v_add_f32 v167, 1.0, v167
    v_rcp_f32 v164, v164
    v_rcp_f32 v165, v165
    v_rcp_f32 v166, v166
    v_rcp_f32 v167, v167
    v_mul_f32 v164, v160, v164
    v_mul_f32 v165, v161, v165
    v_mul_f32 v166, v162, v166
    v_mul_f32 v167, v163, v167
    v_cvt_pk_bf16_f32 v172, v164, v165
    v_cvt_pk_bf16_f32 v173, v166, v167
    v_lshlrev_b32 v164, 16, v172
    v_and_b32 v165, 0xffff0000, v172
    v_lshlrev_b32 v166, 16, v173
    v_and_b32 v167, 0xffff0000, v173
    v_cvt_pk_bf16_f32 v174, v76, v77
    v_cvt_pk_bf16_f32 v175, v78, v79
    v_lshlrev_b32 v168, 16, v174
    v_and_b32 v169, 0xffff0000, v174
    v_lshlrev_b32 v170, 16, v175
    v_and_b32 v171, 0xffff0000, v175
    v_mul_f32 v164, v164, v168
    v_mul_f32 v165, v165, v169
    v_mul_f32 v166, v166, v170
    v_mul_f32 v167, v167, v171
    v_cvt_pk_bf16_f32 v176, v164, v165
    v_cvt_pk_bf16_f32 v177, v166, v167
    s_add_u32 s55, s61, 0xe200
    buffer_store_dwordx2 v[176:177], v6, s[28:31], s55 offen sc1
    v_cvt_pk_bf16_f32 v172, v80, v81
    v_cvt_pk_bf16_f32 v173, v82, v83
    v_lshlrev_b32 v160, 16, v172
    v_and_b32 v161, 0xffff0000, v172
    v_lshlrev_b32 v162, 16, v173
    v_and_b32 v163, 0xffff0000, v173
    v_mul_f32 v164, v160, v160
    v_mul_f32 v165, v161, v161
    v_mul_f32 v166, v162, v162
    v_mul_f32 v167, v163, v163
    v_fma_f32 v164, v164, v205, v204
    v_fma_f32 v165, v165, v205, v204
    v_fma_f32 v166, v166, v205, v204
    v_fma_f32 v167, v167, v205, v204
    v_mul_f32 v164, v160, v164
    v_mul_f32 v165, v161, v165
    v_mul_f32 v166, v162, v166
    v_mul_f32 v167, v163, v167
    v_exp_f32 v164, v164
    v_exp_f32 v165, v165
    v_exp_f32 v166, v166
    v_exp_f32 v167, v167
    v_add_f32 v164, 1.0, v164
    v_add_f32 v165, 1.0, v165
    v_add_f32 v166, 1.0, v166
    v_add_f32 v167, 1.0, v167
    v_rcp_f32 v164, v164
    v_rcp_f32 v165, v165
    v_rcp_f32 v166, v166
    v_rcp_f32 v167, v167
    v_mul_f32 v164, v160, v164
    v_mul_f32 v165, v161, v165
    v_mul_f32 v166, v162, v166
    v_mul_f32 v167, v163, v167
    v_cvt_pk_bf16_f32 v172, v164, v165
    v_cvt_pk_bf16_f32 v173, v166, v167
    v_lshlrev_b32 v164, 16, v172
    v_and_b32 v165, 0xffff0000, v172
    v_lshlrev_b32 v166, 16, v173
    v_and_b32 v167, 0xffff0000, v173
    v_cvt_pk_bf16_f32 v174, v88, v89
    v_cvt_pk_bf16_f32 v175, v90, v91
    v_lshlrev_b32 v168, 16, v174
    v_and_b32 v169, 0xffff0000, v174
    v_lshlrev_b32 v170, 16, v175
    v_and_b32 v171, 0xffff0000, v175
    v_mul_f32 v164, v164, v168
    v_mul_f32 v165, v165, v169
    v_mul_f32 v166, v166, v170
    v_mul_f32 v167, v167, v171
    v_cvt_pk_bf16_f32 v176, v164, v165
    v_cvt_pk_bf16_f32 v177, v166, v167
    s_add_u32 s55, s61, 0x400
    buffer_store_dwordx2 v[176:177], v6, s[28:31], s55 offen sc1
    v_cvt_pk_bf16_f32 v172, v84, v85
    v_cvt_pk_bf16_f32 v173, v86, v87
    v_lshlrev_b32 v160, 16, v172
    v_and_b32 v161, 0xffff0000, v172
    v_lshlrev_b32 v162, 16, v173
    v_and_b32 v163, 0xffff0000, v173
    v_mul_f32 v164, v160, v160
    v_mul_f32 v165, v161, v161
    v_mul_f32 v166, v162, v162
    v_mul_f32 v167, v163, v163
    v_fma_f32 v164, v164, v205, v204
    v_fma_f32 v165, v165, v205, v204
    v_fma_f32 v166, v166, v205, v204
    v_fma_f32 v167, v167, v205, v204
    v_mul_f32 v164, v160, v164
    v_mul_f32 v165, v161, v165
    v_mul_f32 v166, v162, v166
    v_mul_f32 v167, v163, v167
    v_exp_f32 v164, v164
    v_exp_f32 v165, v165
    v_exp_f32 v166, v166
    v_exp_f32 v167, v167
    v_add_f32 v164, 1.0, v164
    v_add_f32 v165, 1.0, v165
    v_add_f32 v166, 1.0, v166
    v_add_f32 v167, 1.0, v167
    v_rcp_f32 v164, v164
    v_rcp_f32 v165, v165
    v_rcp_f32 v166, v166
    v_rcp_f32 v167, v167
    v_mul_f32 v164, v160, v164
    v_mul_f32 v165, v161, v165
    v_mul_f32 v166, v162, v166
    v_mul_f32 v167, v163, v167
    v_cvt_pk_bf16_f32 v172, v164, v165
    v_cvt_pk_bf16_f32 v173, v166, v167
    v_lshlrev_b32 v164, 16, v172
    v_and_b32 v165, 0xffff0000, v172
    v_lshlrev_b32 v166, 16, v173
    v_and_b32 v167, 0xffff0000, v173
    v_cvt_pk_bf16_f32 v174, v92, v93
    v_cvt_pk_bf16_f32 v175, v94, v95
    v_lshlrev_b32 v168, 16, v174
    v_and_b32 v169, 0xffff0000, v174
    v_lshlrev_b32 v170, 16, v175
    v_and_b32 v171, 0xffff0000, v175
    v_mul_f32 v164, v164, v168
    v_mul_f32 v165, v165, v169
    v_mul_f32 v166, v166, v170
    v_mul_f32 v167, v167, v171
    v_cvt_pk_bf16_f32 v176, v164, v165
    v_cvt_pk_bf16_f32 v177, v166, v167
    s_add_u32 s55, s61, 0xe400
    buffer_store_dwordx2 v[176:177], v6, s[28:31], s55 offen sc1
    s_waitcnt lgkmcnt(0)
    s_barrier
    s_mul_i32 s60, s33, 2048
    s_add_u32 s60, s60, 0x1300000
    s_lshl_b32 s55, s34, 13
    s_add_u32 s55, s55, 81920
    v_add_u32 v10, s55, v1
    s_cmp_ge_u32 s34, 2
    s_cbranch_scc1 K1_Q1K1F3_RED_SKIP
    ds_read_b128 v[160:163], v10 offset:0
    ds_read_b128 v[164:167], v10 offset:1024
    ds_read_b128 v[168:171], v10 offset:2048
    ds_read_b128 v[172:175], v10 offset:3072
    ds_read_b128 v[176:179], v10 offset:4096
    ds_read_b128 v[180:183], v10 offset:5120
    ds_read_b128 v[184:187], v10 offset:6144
    ds_read_b128 v[188:191], v10 offset:7168
    s_waitcnt lgkmcnt(6)
    v_add_f32 v160, v160, v164
    s_waitcnt lgkmcnt(4)
    v_add_f32 v168, v168, v172
    s_waitcnt lgkmcnt(2)
    v_add_f32 v176, v176, v180
    s_waitcnt lgkmcnt(0)
    v_add_f32 v184, v184, v188
    v_add_f32 v161, v161, v165
    v_add_f32 v169, v169, v173
    v_add_f32 v177, v177, v181
    v_add_f32 v185, v185, v189
    v_add_f32 v162, v162, v166
    v_add_f32 v170, v170, v174
    v_add_f32 v178, v178, v182
    v_add_f32 v186, v186, v190
    v_add_f32 v163, v163, v167
    v_add_f32 v171, v171, v175
    v_add_f32 v179, v179, v183
    v_add_f32 v187, v187, v191
    v_add_f32 v160, v160, v168
    v_add_f32 v176, v176, v184
    v_add_f32 v161, v161, v169
    v_add_f32 v177, v177, v185
    v_add_f32 v162, v162, v170
    v_add_f32 v178, v178, v186
    v_add_f32 v163, v163, v171
    v_add_f32 v179, v179, v187
    v_add_f32 v160, v160, v176
    v_add_f32 v161, v161, v177
    v_add_f32 v162, v162, v178
    v_add_f32 v163, v163, v179
    s_lshl_b32 s55, s34, 10
    s_add_u32 s55, s55, s60
    buffer_atomic_add_f32 v160, v8, s[28:31], s55 offen offset:0
    buffer_atomic_add_f32 v161, v8, s[28:31], s55 offen offset:256
    buffer_atomic_add_f32 v162, v8, s[28:31], s55 offen offset:512
    buffer_atomic_add_f32 v163, v8, s[28:31], s55 offen offset:768
K1_Q1K1F3_RED_SKIP:
    s_branch K1_END
K1_V_K1F4:
    s_mul_i32 s36, s33, 16384
    s_add_u32 s36, s36, 0x280000
    s_mul_i32 s37, s33, 16384
    s_add_u32 s37, s37, 0x300000
    s_mul_i32 s38, s33, 65536
    s_add_u32 s38, s38, 0x340000
    s_mul_i32 s39, s33, 65536
    s_add_u32 s39, s39, 0x500000
    s_mul_i32 s40, s33, 65536
    s_add_u32 s40, s40, 0x344000
    s_mul_i32 s41, s33, 65536
    s_add_u32 s41, s41, 0x504000
    s_mul_i32 s42, s33, 65536
    s_add_u32 s42, s42, 0x348000
    s_mul_i32 s43, s33, 65536
    s_add_u32 s43, s43, 0x508000
    s_mul_i32 s44, s33, 65536
    s_add_u32 s44, s44, 0x34c000
    s_mul_i32 s45, s33, 65536
    s_add_u32 s45, s45, 0x50c000
    s_lshr_b32 s55, s34, 1
    s_lshl_b32 s56, s55, 10
    s_mul_i32 s51, s55, 10240
    s_and_b32 s57, s34, 1
    s_cselect_b32 s46, s41, s36
    s_cselect_b32 s47, s42, s37
    s_cselect_b32 s48, s43, s38
    s_cselect_b32 s49, s44, s39
    s_cselect_b32 s50, s45, s40
    s_add_u32 s46, s46, s56
    s_add_u32 s47, s47, s56
    s_add_u32 s48, s48, s56
    s_add_u32 s49, s49, s56
    s_add_u32 s50, s50, s56
    s_mul_i32 s57, s57, 5120
    s_add_u32 s51, s51, s57
    s_add_u32 m0, s51, 0
    s_add_u32 s55, s46, 0
    buffer_load_dwordx4 v1, s[28:31], s55 offen lds
    s_add_u32 m0, s51, 1024
    s_add_u32 s55, s47, 0
    buffer_load_dwordx4 v1, s[28:31], s55 offen lds
    s_add_u32 m0, s51, 2048
    s_add_u32 s55, s48, 0
    buffer_load_dwordx4 v1, s[28:31], s55 offen lds
    s_add_u32 m0, s51, 3072
    s_add_u32 s55, s49, 0
    buffer_load_dwordx4 v1, s[28:31], s55 offen lds
    s_add_u32 m0, s51, 4096
    s_add_u32 s55, s50, 0
    buffer_load_dwordx4 v1, s[28:31], s55 offen lds
    s_add_u32 m0, s51, 40960
    s_add_u32 s55, s46, 4096
    buffer_load_dwordx4 v1, s[28:31], s55 offen lds
    s_add_u32 m0, s51, 41984
    s_add_u32 s55, s47, 4096
    buffer_load_dwordx4 v1, s[28:31], s55 offen lds
    s_add_u32 m0, s51, 43008
    s_add_u32 s55, s48, 4096
    buffer_load_dwordx4 v1, s[28:31], s55 offen lds
    s_add_u32 m0, s51, 44032
    s_add_u32 s55, s49, 4096
    buffer_load_dwordx4 v1, s[28:31], s55 offen lds
    s_add_u32 m0, s51, 45056
    s_add_u32 s55, s50, 4096
    buffer_load_dwordx4 v1, s[28:31], s55 offen lds
    buffer_load_dwordx4 v[96:99], v2, s[28:31], 0 offen offset:0
    buffer_load_dwordx4 v[100:103], v3, s[28:31], 0 offen offset:0
    buffer_load_dwordx4 v[104:107], v2, s[28:31], 0 offen offset:1024
    buffer_load_dwordx4 v[108:111], v3, s[28:31], 0 offen offset:1024
    s_waitcnt vmcnt(9)
    s_barrier
    ds_read_b128 v[120:123], v4 offset:0
    ds_read_b128 v[124:127], v4 offset:1024
    ds_read_b128 v[128:131], v4 offset:2048
    ds_read_b128 v[132:135], v4 offset:3072
    ds_read_b128 v[136:139], v4 offset:4096
    buffer_load_dwordx4 v[112:115], v2, s[28:31], 0 offen offset:2048
    buffer_load_dwordx4 v[116:119], v3, s[28:31], 0 offen offset:2048
    ds_read_b128 v[140:143], v4 offset:5120
    ds_read_b128 v[144:147], v4 offset:6144
    ds_read_b128 v[148:151], v4 offset:7168
    ds_read_b128 v[152:155], v4 offset:8192
    ds_read_b128 v[156:159], v4 offset:9216
    s_waitcnt vmcnt(5)
    s_waitcnt lgkmcnt(9)
    v_mfma_f32_16x16x32_bf16 v[16:19], v[96:99], v[120:123], 0
    s_waitcnt vmcnt(4)
    v_mfma_f32_16x16x32_bf16 v[20:23], v[100:103], v[120:123], 0
    s_waitcnt lgkmcnt(8)
    v_mfma_f32_16x16x32_bf16 v[24:27], v[96:99], v[124:127], 0
    v_mfma_f32_16x16x32_bf16 v[28:31], v[100:103], v[124:127], 0
    s_waitcnt lgkmcnt(7)
    v_mfma_f32_16x16x32_bf16 v[32:35], v[128:131], v[96:99], 0
    v_mfma_f32_16x16x32_bf16 v[36:39], v[128:131], v[100:103], 0
    s_waitcnt lgkmcnt(6)
    v_mfma_f32_16x16x32_bf16 v[40:43], v[132:135], v[96:99], 0
    v_mfma_f32_16x16x32_bf16 v[44:47], v[132:135], v[100:103], 0
    s_waitcnt lgkmcnt(5)
    v_mfma_f32_16x16x32_bf16 v[48:51], v[136:139], v[96:99], 0
    v_mfma_f32_16x16x32_bf16 v[52:55], v[136:139], v[100:103], 0
    ds_read_b128 v[120:123], v4 offset:10240
    ds_read_b128 v[124:127], v4 offset:11264
    ds_read_b128 v[128:131], v4 offset:12288
    ds_read_b128 v[132:135], v4 offset:13312
    ds_read_b128 v[136:139], v4 offset:14336
    s_waitcnt lgkmcnt(9)
    v_mfma_f32_16x16x32_bf16 v[56:59], v[140:143], v[96:99], 0
    v_mfma_f32_16x16x32_bf16 v[60:63], v[140:143], v[100:103], 0
    s_waitcnt lgkmcnt(8)
    v_mfma_f32_16x16x32_bf16 v[64:67], v[144:147], v[96:99], 0
    v_mfma_f32_16x16x32_bf16 v[68:71], v[144:147], v[100:103], 0
    s_waitcnt lgkmcnt(7)
    v_mfma_f32_16x16x32_bf16 v[72:75], v[148:151], v[96:99], 0
    v_mfma_f32_16x16x32_bf16 v[76:79], v[148:151], v[100:103], 0
    s_waitcnt lgkmcnt(6)
    v_mfma_f32_16x16x32_bf16 v[80:83], v[152:155], v[96:99], 0
    v_mfma_f32_16x16x32_bf16 v[84:87], v[152:155], v[100:103], 0
    s_waitcnt lgkmcnt(5)
    v_mfma_f32_16x16x32_bf16 v[88:91], v[156:159], v[96:99], 0
    v_mfma_f32_16x16x32_bf16 v[92:95], v[156:159], v[100:103], 0
    buffer_load_dwordx4 v[96:99], v2, s[28:31], 0 offen offset:3072
    buffer_load_dwordx4 v[100:103], v3, s[28:31], 0 offen offset:3072
    ds_read_b128 v[140:143], v4 offset:15360
    ds_read_b128 v[144:147], v4 offset:16384
    ds_read_b128 v[148:151], v4 offset:17408
    ds_read_b128 v[152:155], v4 offset:18432
    ds_read_b128 v[156:159], v4 offset:19456
    s_waitcnt vmcnt(5)
    s_waitcnt lgkmcnt(9)
    v_mfma_f32_16x16x32_bf16 v[16:19], v[104:107], v[120:123], v[16:19]
    s_waitcnt vmcnt(4)
    v_mfma_f32_16x16x32_bf16 v[20:23], v[108:111], v[120:123], v[20:23]
    s_waitcnt lgkmcnt(8)
    v_mfma_f32_16x16x32_bf16 v[24:27], v[104:107], v[124:127], v[24:27]
    v_mfma_f32_16x16x32_bf16 v[28:31], v[108:111], v[124:127], v[28:31]
    s_waitcnt lgkmcnt(7)
    v_mfma_f32_16x16x32_bf16 v[32:35], v[128:131], v[104:107], v[32:35]
    v_mfma_f32_16x16x32_bf16 v[36:39], v[128:131], v[108:111], v[36:39]
    s_waitcnt lgkmcnt(6)
    v_mfma_f32_16x16x32_bf16 v[40:43], v[132:135], v[104:107], v[40:43]
    v_mfma_f32_16x16x32_bf16 v[44:47], v[132:135], v[108:111], v[44:47]
    s_waitcnt lgkmcnt(5)
    v_mfma_f32_16x16x32_bf16 v[48:51], v[136:139], v[104:107], v[48:51]
    v_mfma_f32_16x16x32_bf16 v[52:55], v[136:139], v[108:111], v[52:55]
    ds_read_b128 v[120:123], v4 offset:20480
    ds_read_b128 v[124:127], v4 offset:21504
    ds_read_b128 v[128:131], v4 offset:22528
    ds_read_b128 v[132:135], v4 offset:23552
    ds_read_b128 v[136:139], v4 offset:24576
    s_waitcnt lgkmcnt(9)
    v_mfma_f32_16x16x32_bf16 v[56:59], v[140:143], v[104:107], v[56:59]
    v_mfma_f32_16x16x32_bf16 v[60:63], v[140:143], v[108:111], v[60:63]
    s_waitcnt lgkmcnt(8)
    v_mfma_f32_16x16x32_bf16 v[64:67], v[144:147], v[104:107], v[64:67]
    v_mfma_f32_16x16x32_bf16 v[68:71], v[144:147], v[108:111], v[68:71]
    s_waitcnt lgkmcnt(7)
    v_mfma_f32_16x16x32_bf16 v[72:75], v[148:151], v[104:107], v[72:75]
    v_mfma_f32_16x16x32_bf16 v[76:79], v[148:151], v[108:111], v[76:79]
    s_waitcnt lgkmcnt(6)
    v_mfma_f32_16x16x32_bf16 v[80:83], v[152:155], v[104:107], v[80:83]
    v_mfma_f32_16x16x32_bf16 v[84:87], v[152:155], v[108:111], v[84:87]
    s_waitcnt lgkmcnt(5)
    v_mfma_f32_16x16x32_bf16 v[88:91], v[156:159], v[104:107], v[88:91]
    v_mfma_f32_16x16x32_bf16 v[92:95], v[156:159], v[108:111], v[92:95]
    buffer_load_dwordx4 v[104:107], v2, s[28:31], s52 offen offset:0
    buffer_load_dwordx4 v[108:111], v3, s[28:31], s52 offen offset:0
    ds_read_b128 v[140:143], v4 offset:25600
    ds_read_b128 v[144:147], v4 offset:26624
    ds_read_b128 v[148:151], v4 offset:27648
    ds_read_b128 v[152:155], v4 offset:28672
    ds_read_b128 v[156:159], v4 offset:29696
    s_waitcnt vmcnt(5)
    s_waitcnt lgkmcnt(9)
    v_mfma_f32_16x16x32_bf16 v[16:19], v[112:115], v[120:123], v[16:19]
    s_waitcnt vmcnt(4)
    v_mfma_f32_16x16x32_bf16 v[20:23], v[116:119], v[120:123], v[20:23]
    s_waitcnt lgkmcnt(8)
    v_mfma_f32_16x16x32_bf16 v[24:27], v[112:115], v[124:127], v[24:27]
    v_mfma_f32_16x16x32_bf16 v[28:31], v[116:119], v[124:127], v[28:31]
    s_waitcnt lgkmcnt(7)
    v_mfma_f32_16x16x32_bf16 v[32:35], v[128:131], v[112:115], v[32:35]
    v_mfma_f32_16x16x32_bf16 v[36:39], v[128:131], v[116:119], v[36:39]
    s_waitcnt lgkmcnt(6)
    v_mfma_f32_16x16x32_bf16 v[40:43], v[132:135], v[112:115], v[40:43]
    v_mfma_f32_16x16x32_bf16 v[44:47], v[132:135], v[116:119], v[44:47]
    s_waitcnt lgkmcnt(5)
    v_mfma_f32_16x16x32_bf16 v[48:51], v[136:139], v[112:115], v[48:51]
    v_mfma_f32_16x16x32_bf16 v[52:55], v[136:139], v[116:119], v[52:55]
    ds_read_b128 v[120:123], v4 offset:30720
    ds_read_b128 v[124:127], v4 offset:31744
    ds_read_b128 v[128:131], v4 offset:32768
    ds_read_b128 v[132:135], v4 offset:33792
    ds_read_b128 v[136:139], v4 offset:34816
    s_waitcnt lgkmcnt(9)
    v_mfma_f32_16x16x32_bf16 v[56:59], v[140:143], v[112:115], v[56:59]
    v_mfma_f32_16x16x32_bf16 v[60:63], v[140:143], v[116:119], v[60:63]
    s_waitcnt lgkmcnt(8)
    v_mfma_f32_16x16x32_bf16 v[64:67], v[144:147], v[112:115], v[64:67]
    v_mfma_f32_16x16x32_bf16 v[68:71], v[144:147], v[116:119], v[68:71]
    s_waitcnt lgkmcnt(7)
    v_mfma_f32_16x16x32_bf16 v[72:75], v[148:151], v[112:115], v[72:75]
    v_mfma_f32_16x16x32_bf16 v[76:79], v[148:151], v[116:119], v[76:79]
    s_waitcnt lgkmcnt(6)
    v_mfma_f32_16x16x32_bf16 v[80:83], v[152:155], v[112:115], v[80:83]
    v_mfma_f32_16x16x32_bf16 v[84:87], v[152:155], v[116:119], v[84:87]
    s_waitcnt lgkmcnt(5)
    v_mfma_f32_16x16x32_bf16 v[88:91], v[156:159], v[112:115], v[88:91]
    v_mfma_f32_16x16x32_bf16 v[92:95], v[156:159], v[116:119], v[92:95]
    buffer_load_dwordx4 v[112:115], v2, s[28:31], s52 offen offset:1024
    buffer_load_dwordx4 v[116:119], v3, s[28:31], s52 offen offset:1024
    ds_read_b128 v[140:143], v4 offset:35840
    ds_read_b128 v[144:147], v4 offset:36864
    ds_read_b128 v[148:151], v4 offset:37888
    ds_read_b128 v[152:155], v4 offset:38912
    ds_read_b128 v[156:159], v4 offset:39936
    s_waitcnt vmcnt(5)
    s_waitcnt lgkmcnt(9)
    v_mfma_f32_16x16x32_bf16 v[16:19], v[96:99], v[120:123], v[16:19]
    s_waitcnt vmcnt(4)
    v_mfma_f32_16x16x32_bf16 v[20:23], v[100:103], v[120:123], v[20:23]
    s_waitcnt lgkmcnt(8)
    v_mfma_f32_16x16x32_bf16 v[24:27], v[96:99], v[124:127], v[24:27]
    v_mfma_f32_16x16x32_bf16 v[28:31], v[100:103], v[124:127], v[28:31]
    s_waitcnt lgkmcnt(7)
    v_mfma_f32_16x16x32_bf16 v[32:35], v[128:131], v[96:99], v[32:35]
    v_mfma_f32_16x16x32_bf16 v[36:39], v[128:131], v[100:103], v[36:39]
    s_waitcnt lgkmcnt(6)
    v_mfma_f32_16x16x32_bf16 v[40:43], v[132:135], v[96:99], v[40:43]
    v_mfma_f32_16x16x32_bf16 v[44:47], v[132:135], v[100:103], v[44:47]
    s_waitcnt lgkmcnt(5)
    v_mfma_f32_16x16x32_bf16 v[48:51], v[136:139], v[96:99], v[48:51]
    v_mfma_f32_16x16x32_bf16 v[52:55], v[136:139], v[100:103], v[52:55]
    s_waitcnt lgkmcnt(4)
    v_mfma_f32_16x16x32_bf16 v[56:59], v[140:143], v[96:99], v[56:59]
    v_mfma_f32_16x16x32_bf16 v[60:63], v[140:143], v[100:103], v[60:63]
    s_waitcnt lgkmcnt(3)
    v_mfma_f32_16x16x32_bf16 v[64:67], v[144:147], v[96:99], v[64:67]
    v_mfma_f32_16x16x32_bf16 v[68:71], v[144:147], v[100:103], v[68:71]
    s_waitcnt lgkmcnt(2)
    v_mfma_f32_16x16x32_bf16 v[72:75], v[148:151], v[96:99], v[72:75]
    v_mfma_f32_16x16x32_bf16 v[76:79], v[148:151], v[100:103], v[76:79]
    s_waitcnt lgkmcnt(1)
    v_mfma_f32_16x16x32_bf16 v[80:83], v[152:155], v[96:99], v[80:83]
    v_mfma_f32_16x16x32_bf16 v[84:87], v[152:155], v[100:103], v[84:87]
    s_waitcnt lgkmcnt(0)
    v_mfma_f32_16x16x32_bf16 v[88:91], v[156:159], v[96:99], v[88:91]
    v_mfma_f32_16x16x32_bf16 v[92:95], v[156:159], v[100:103], v[92:95]
    s_barrier
    ds_read_b128 v[120:123], v5 offset:0
    ds_read_b128 v[124:127], v5 offset:1024
    ds_read_b128 v[128:131], v5 offset:2048
    ds_read_b128 v[132:135], v5 offset:3072
    ds_read_b128 v[136:139], v5 offset:4096
    s_add_u32 m0, s51, 0
    s_add_u32 s55, s46, 8192
    buffer_load_dwordx4 v1, s[28:31], s55 offen lds
    s_add_u32 m0, s51, 1024
    s_add_u32 s55, s47, 8192
    buffer_load_dwordx4 v1, s[28:31], s55 offen lds
    s_add_u32 m0, s51, 2048
    s_add_u32 s55, s48, 8192
    buffer_load_dwordx4 v1, s[28:31], s55 offen lds
    s_add_u32 m0, s51, 3072
    s_add_u32 s55, s49, 8192
    buffer_load_dwordx4 v1, s[28:31], s55 offen lds
    s_add_u32 m0, s51, 4096
    s_add_u32 s55, s50, 8192
    buffer_load_dwordx4 v1, s[28:31], s55 offen lds
    buffer_load_dwordx4 v[96:99], v2, s[28:31], s52 offen offset:2048
    buffer_load_dwordx4 v[100:103], v3, s[28:31], s52 offen offset:2048
    ds_read_b128 v[140:143], v5 offset:5120
    ds_read_b128 v[144:147], v5 offset:6144
    ds_read_b128 v[148:151], v5 offset:7168
    ds_read_b128 v[152:155], v5 offset:8192
    ds_read_b128 v[156:159], v5 offset:9216
    s_waitcnt vmcnt(10)
    s_waitcnt lgkmcnt(9)
    v_mfma_f32_16x16x32_bf16 v[16:19], v[104:107], v[120:123], v[16:19]
    s_waitcnt vmcnt(9)
    v_mfma_f32_16x16x32_bf16 v[20:23], v[108:111], v[120:123], v[20:23]
    s_waitcnt lgkmcnt(8)
    v_mfma_f32_16x16x32_bf16 v[24:27], v[104:107], v[124:127], v[24:27]
    v_mfma_f32_16x16x32_bf16 v[28:31], v[108:111], v[124:127], v[28:31]
    s_waitcnt lgkmcnt(7)
    v_mfma_f32_16x16x32_bf16 v[32:35], v[128:131], v[104:107], v[32:35]
    v_mfma_f32_16x16x32_bf16 v[36:39], v[128:131], v[108:111], v[36:39]
    s_waitcnt lgkmcnt(6)
    v_mfma_f32_16x16x32_bf16 v[40:43], v[132:135], v[104:107], v[40:43]
    v_mfma_f32_16x16x32_bf16 v[44:47], v[132:135], v[108:111], v[44:47]
    s_waitcnt lgkmcnt(5)
    v_mfma_f32_16x16x32_bf16 v[48:51], v[136:139], v[104:107], v[48:51]
    v_mfma_f32_16x16x32_bf16 v[52:55], v[136:139], v[108:111], v[52:55]
    ds_read_b128 v[120:123], v5 offset:10240
    ds_read_b128 v[124:127], v5 offset:11264
    ds_read_b128 v[128:131], v5 offset:12288
    ds_read_b128 v[132:135], v5 offset:13312
    ds_read_b128 v[136:139], v5 offset:14336
    s_waitcnt lgkmcnt(9)
    v_mfma_f32_16x16x32_bf16 v[56:59], v[140:143], v[104:107], v[56:59]
    v_mfma_f32_16x16x32_bf16 v[60:63], v[140:143], v[108:111], v[60:63]
    s_waitcnt lgkmcnt(8)
    v_mfma_f32_16x16x32_bf16 v[64:67], v[144:147], v[104:107], v[64:67]
    v_mfma_f32_16x16x32_bf16 v[68:71], v[144:147], v[108:111], v[68:71]
    s_waitcnt lgkmcnt(7)
    v_mfma_f32_16x16x32_bf16 v[72:75], v[148:151], v[104:107], v[72:75]
    v_mfma_f32_16x16x32_bf16 v[76:79], v[148:151], v[108:111], v[76:79]
    s_waitcnt lgkmcnt(6)
    v_mfma_f32_16x16x32_bf16 v[80:83], v[152:155], v[104:107], v[80:83]
    v_mfma_f32_16x16x32_bf16 v[84:87], v[152:155], v[108:111], v[84:87]
    s_waitcnt lgkmcnt(5)
    v_mfma_f32_16x16x32_bf16 v[88:91], v[156:159], v[104:107], v[88:91]
    v_mfma_f32_16x16x32_bf16 v[92:95], v[156:159], v[108:111], v[92:95]
    buffer_load_dwordx4 v[104:107], v2, s[28:31], s52 offen offset:3072
    buffer_load_dwordx4 v[108:111], v3, s[28:31], s52 offen offset:3072
    ds_read_b128 v[140:143], v5 offset:15360
    ds_read_b128 v[144:147], v5 offset:16384
    ds_read_b128 v[148:151], v5 offset:17408
    ds_read_b128 v[152:155], v5 offset:18432
    ds_read_b128 v[156:159], v5 offset:19456
    s_waitcnt vmcnt(10)
    s_waitcnt lgkmcnt(9)
    v_mfma_f32_16x16x32_bf16 v[16:19], v[112:115], v[120:123], v[16:19]
    s_waitcnt vmcnt(9)
    v_mfma_f32_16x16x32_bf16 v[20:23], v[116:119], v[120:123], v[20:23]
    s_waitcnt lgkmcnt(8)
    v_mfma_f32_16x16x32_bf16 v[24:27], v[112:115], v[124:127], v[24:27]
    v_mfma_f32_16x16x32_bf16 v[28:31], v[116:119], v[124:127], v[28:31]
    s_waitcnt lgkmcnt(7)
    v_mfma_f32_16x16x32_bf16 v[32:35], v[128:131], v[112:115], v[32:35]
    v_mfma_f32_16x16x32_bf16 v[36:39], v[128:131], v[116:119], v[36:39]
    s_waitcnt lgkmcnt(6)
    v_mfma_f32_16x16x32_bf16 v[40:43], v[132:135], v[112:115], v[40:43]
    v_mfma_f32_16x16x32_bf16 v[44:47], v[132:135], v[116:119], v[44:47]
    s_waitcnt lgkmcnt(5)
    v_mfma_f32_16x16x32_bf16 v[48:51], v[136:139], v[112:115], v[48:51]
    v_mfma_f32_16x16x32_bf16 v[52:55], v[136:139], v[116:119], v[52:55]
    ds_read_b128 v[120:123], v5 offset:20480
    ds_read_b128 v[124:127], v5 offset:21504
    ds_read_b128 v[128:131], v5 offset:22528
    ds_read_b128 v[132:135], v5 offset:23552
    ds_read_b128 v[136:139], v5 offset:24576
    s_waitcnt lgkmcnt(9)
    v_mfma_f32_16x16x32_bf16 v[56:59], v[140:143], v[112:115], v[56:59]
    v_mfma_f32_16x16x32_bf16 v[60:63], v[140:143], v[116:119], v[60:63]
    s_waitcnt lgkmcnt(8)
    v_mfma_f32_16x16x32_bf16 v[64:67], v[144:147], v[112:115], v[64:67]
    v_mfma_f32_16x16x32_bf16 v[68:71], v[144:147], v[116:119], v[68:71]
    s_waitcnt lgkmcnt(7)
    v_mfma_f32_16x16x32_bf16 v[72:75], v[148:151], v[112:115], v[72:75]
    v_mfma_f32_16x16x32_bf16 v[76:79], v[148:151], v[116:119], v[76:79]
    s_waitcnt lgkmcnt(6)
    v_mfma_f32_16x16x32_bf16 v[80:83], v[152:155], v[112:115], v[80:83]
    v_mfma_f32_16x16x32_bf16 v[84:87], v[152:155], v[116:119], v[84:87]
    s_waitcnt lgkmcnt(5)
    v_mfma_f32_16x16x32_bf16 v[88:91], v[156:159], v[112:115], v[88:91]
    v_mfma_f32_16x16x32_bf16 v[92:95], v[156:159], v[116:119], v[92:95]
    buffer_load_dwordx4 v[112:115], v2, s[28:31], s53 offen offset:0
    buffer_load_dwordx4 v[116:119], v3, s[28:31], s53 offen offset:0
    ds_read_b128 v[140:143], v5 offset:25600
    ds_read_b128 v[144:147], v5 offset:26624
    ds_read_b128 v[148:151], v5 offset:27648
    ds_read_b128 v[152:155], v5 offset:28672
    ds_read_b128 v[156:159], v5 offset:29696
    s_waitcnt vmcnt(5)
    s_waitcnt lgkmcnt(9)
    v_mfma_f32_16x16x32_bf16 v[16:19], v[96:99], v[120:123], v[16:19]
    s_waitcnt vmcnt(4)
    v_mfma_f32_16x16x32_bf16 v[20:23], v[100:103], v[120:123], v[20:23]
    s_waitcnt lgkmcnt(8)
    v_mfma_f32_16x16x32_bf16 v[24:27], v[96:99], v[124:127], v[24:27]
    v_mfma_f32_16x16x32_bf16 v[28:31], v[100:103], v[124:127], v[28:31]
    s_waitcnt lgkmcnt(7)
    v_mfma_f32_16x16x32_bf16 v[32:35], v[128:131], v[96:99], v[32:35]
    v_mfma_f32_16x16x32_bf16 v[36:39], v[128:131], v[100:103], v[36:39]
    s_waitcnt lgkmcnt(6)
    v_mfma_f32_16x16x32_bf16 v[40:43], v[132:135], v[96:99], v[40:43]
    v_mfma_f32_16x16x32_bf16 v[44:47], v[132:135], v[100:103], v[44:47]
    s_waitcnt lgkmcnt(5)
    v_mfma_f32_16x16x32_bf16 v[48:51], v[136:139], v[96:99], v[48:51]
    v_mfma_f32_16x16x32_bf16 v[52:55], v[136:139], v[100:103], v[52:55]
    ds_read_b128 v[120:123], v5 offset:30720
    ds_read_b128 v[124:127], v5 offset:31744
    ds_read_b128 v[128:131], v5 offset:32768
    ds_read_b128 v[132:135], v5 offset:33792
    ds_read_b128 v[136:139], v5 offset:34816
    s_waitcnt lgkmcnt(9)
    v_mfma_f32_16x16x32_bf16 v[56:59], v[140:143], v[96:99], v[56:59]
    v_mfma_f32_16x16x32_bf16 v[60:63], v[140:143], v[100:103], v[60:63]
    s_waitcnt lgkmcnt(8)
    v_mfma_f32_16x16x32_bf16 v[64:67], v[144:147], v[96:99], v[64:67]
    v_mfma_f32_16x16x32_bf16 v[68:71], v[144:147], v[100:103], v[68:71]
    s_waitcnt lgkmcnt(7)
    v_mfma_f32_16x16x32_bf16 v[72:75], v[148:151], v[96:99], v[72:75]
    v_mfma_f32_16x16x32_bf16 v[76:79], v[148:151], v[100:103], v[76:79]
    s_waitcnt lgkmcnt(6)
    v_mfma_f32_16x16x32_bf16 v[80:83], v[152:155], v[96:99], v[80:83]
    v_mfma_f32_16x16x32_bf16 v[84:87], v[152:155], v[100:103], v[84:87]
    s_waitcnt lgkmcnt(5)
    v_mfma_f32_16x16x32_bf16 v[88:91], v[156:159], v[96:99], v[88:91]
    v_mfma_f32_16x16x32_bf16 v[92:95], v[156:159], v[100:103], v[92:95]
    buffer_load_dwordx4 v[96:99], v2, s[28:31], s53 offen offset:1024
    buffer_load_dwordx4 v[100:103], v3, s[28:31], s53 offen offset:1024
    ds_read_b128 v[140:143], v5 offset:35840
    ds_read_b128 v[144:147], v5 offset:36864
    ds_read_b128 v[148:151], v5 offset:37888
    ds_read_b128 v[152:155], v5 offset:38912
    ds_read_b128 v[156:159], v5 offset:39936
    s_waitcnt vmcnt(5)
    s_waitcnt lgkmcnt(9)
    v_mfma_f32_16x16x32_bf16 v[16:19], v[104:107], v[120:123], v[16:19]
    s_waitcnt vmcnt(4)
    v_mfma_f32_16x16x32_bf16 v[20:23], v[108:111], v[120:123], v[20:23]
    s_waitcnt lgkmcnt(8)
    v_mfma_f32_16x16x32_bf16 v[24:27], v[104:107], v[124:127], v[24:27]
    v_mfma_f32_16x16x32_bf16 v[28:31], v[108:111], v[124:127], v[28:31]
    s_waitcnt lgkmcnt(7)
    v_mfma_f32_16x16x32_bf16 v[32:35], v[128:131], v[104:107], v[32:35]
    v_mfma_f32_16x16x32_bf16 v[36:39], v[128:131], v[108:111], v[36:39]
    s_waitcnt lgkmcnt(6)
    v_mfma_f32_16x16x32_bf16 v[40:43], v[132:135], v[104:107], v[40:43]
    v_mfma_f32_16x16x32_bf16 v[44:47], v[132:135], v[108:111], v[44:47]
    s_waitcnt lgkmcnt(5)
    v_mfma_f32_16x16x32_bf16 v[48:51], v[136:139], v[104:107], v[48:51]
    v_mfma_f32_16x16x32_bf16 v[52:55], v[136:139], v[108:111], v[52:55]
    s_waitcnt lgkmcnt(4)
    v_mfma_f32_16x16x32_bf16 v[56:59], v[140:143], v[104:107], v[56:59]
    v_mfma_f32_16x16x32_bf16 v[60:63], v[140:143], v[108:111], v[60:63]
    s_waitcnt lgkmcnt(3)
    v_mfma_f32_16x16x32_bf16 v[64:67], v[144:147], v[104:107], v[64:67]
    v_mfma_f32_16x16x32_bf16 v[68:71], v[144:147], v[108:111], v[68:71]
    s_waitcnt lgkmcnt(2)
    v_mfma_f32_16x16x32_bf16 v[72:75], v[148:151], v[104:107], v[72:75]
    v_mfma_f32_16x16x32_bf16 v[76:79], v[148:151], v[108:111], v[76:79]
    s_waitcnt lgkmcnt(1)
    v_mfma_f32_16x16x32_bf16 v[80:83], v[152:155], v[104:107], v[80:83]
    v_mfma_f32_16x16x32_bf16 v[84:87], v[152:155], v[108:111], v[84:87]
    s_waitcnt lgkmcnt(0)
    v_mfma_f32_16x16x32_bf16 v[88:91], v[156:159], v[104:107], v[88:91]
    v_mfma_f32_16x16x32_bf16 v[92:95], v[156:159], v[108:111], v[92:95]
    s_barrier
    ds_read_b128 v[120:123], v4 offset:0
    ds_read_b128 v[124:127], v4 offset:1024
    ds_read_b128 v[128:131], v4 offset:2048
    ds_read_b128 v[132:135], v4 offset:3072
    ds_read_b128 v[136:139], v4 offset:4096
    s_add_u32 m0, s51, 40960
    s_add_u32 s55, s46, 12288
    buffer_load_dwordx4 v1, s[28:31], s55 offen lds
    s_add_u32 m0, s51, 41984
    s_add_u32 s55, s47, 12288
    buffer_load_dwordx4 v1, s[28:31], s55 offen lds
    s_add_u32 m0, s51, 43008
    s_add_u32 s55, s48, 12288
    buffer_load_dwordx4 v1, s[28:31], s55 offen lds
    s_add_u32 m0, s51, 44032
    s_add_u32 s55, s49, 12288
    buffer_load_dwordx4 v1, s[28:31], s55 offen lds
    s_add_u32 m0, s51, 45056
    s_add_u32 s55, s50, 12288
    buffer_load_dwordx4 v1, s[28:31], s55 offen lds
    buffer_load_dwordx4 v[104:107], v2, s[28:31], s53 offen offset:2048
    buffer_load_dwordx4 v[108:111], v3, s[28:31], s53 offen offset:2048
    ds_read_b128 v[140:143], v4 offset:5120
    ds_read_b128 v[144:147], v4 offset:6144
    ds_read_b128 v[148:151], v4 offset:7168
    ds_read_b128 v[152:155], v4 offset:8192
    ds_read_b128 v[156:159], v4 offset:9216
    s_waitcnt vmcnt(10)
    s_waitcnt lgkmcnt(9)
    v_mfma_f32_16x16x32_bf16 v[16:19], v[112:115], v[120:123], v[16:19]
    s_waitcnt vmcnt(9)
    v_mfma_f32_16x16x32_bf16 v[20:23], v[116:119], v[120:123], v[20:23]
    s_waitcnt lgkmcnt(8)
    v_mfma_f32_16x16x32_bf16 v[24:27], v[112:115], v[124:127], v[24:27]
    v_mfma_f32_16x16x32_bf16 v[28:31], v[116:119], v[124:127], v[28:31]
    s_waitcnt lgkmcnt(7)
    v_mfma_f32_16x16x32_bf16 v[32:35], v[128:131], v[112:115], v[32:35]
    v_mfma_f32_16x16x32_bf16 v[36:39], v[128:131], v[116:119], v[36:39]
    s_waitcnt lgkmcnt(6)
    v_mfma_f32_16x16x32_bf16 v[40:43], v[132:135], v[112:115], v[40:43]
    v_mfma_f32_16x16x32_bf16 v[44:47], v[132:135], v[116:119], v[44:47]
    s_waitcnt lgkmcnt(5)
    v_mfma_f32_16x16x32_bf16 v[48:51], v[136:139], v[112:115], v[48:51]
    v_mfma_f32_16x16x32_bf16 v[52:55], v[136:139], v[116:119], v[52:55]
    ds_read_b128 v[120:123], v4 offset:10240
    ds_read_b128 v[124:127], v4 offset:11264
    ds_read_b128 v[128:131], v4 offset:12288
    ds_read_b128 v[132:135], v4 offset:13312
    ds_read_b128 v[136:139], v4 offset:14336
    s_waitcnt lgkmcnt(9)
    v_mfma_f32_16x16x32_bf16 v[56:59], v[140:143], v[112:115], v[56:59]
    v_mfma_f32_16x16x32_bf16 v[60:63], v[140:143], v[116:119], v[60:63]
    s_waitcnt lgkmcnt(8)
    v_mfma_f32_16x16x32_bf16 v[64:67], v[144:147], v[112:115], v[64:67]
    v_mfma_f32_16x16x32_bf16 v[68:71], v[144:147], v[116:119], v[68:71]
    s_waitcnt lgkmcnt(7)
    v_mfma_f32_16x16x32_bf16 v[72:75], v[148:151], v[112:115], v[72:75]
    v_mfma_f32_16x16x32_bf16 v[76:79], v[148:151], v[116:119], v[76:79]
    s_waitcnt lgkmcnt(6)
    v_mfma_f32_16x16x32_bf16 v[80:83], v[152:155], v[112:115], v[80:83]
    v_mfma_f32_16x16x32_bf16 v[84:87], v[152:155], v[116:119], v[84:87]
    s_waitcnt lgkmcnt(5)
    v_mfma_f32_16x16x32_bf16 v[88:91], v[156:159], v[112:115], v[88:91]
    v_mfma_f32_16x16x32_bf16 v[92:95], v[156:159], v[116:119], v[92:95]
    buffer_load_dwordx4 v[112:115], v2, s[28:31], s53 offen offset:3072
    buffer_load_dwordx4 v[116:119], v3, s[28:31], s53 offen offset:3072
    ds_read_b128 v[140:143], v4 offset:15360
    ds_read_b128 v[144:147], v4 offset:16384
    ds_read_b128 v[148:151], v4 offset:17408
    ds_read_b128 v[152:155], v4 offset:18432
    ds_read_b128 v[156:159], v4 offset:19456
    s_waitcnt vmcnt(10)
    s_waitcnt lgkmcnt(9)
    v_mfma_f32_16x16x32_bf16 v[16:19], v[96:99], v[120:123], v[16:19]
    s_waitcnt vmcnt(9)
    v_mfma_f32_16x16x32_bf16 v[20:23], v[100:103], v[120:123], v[20:23]
    s_waitcnt lgkmcnt(8)
    v_mfma_f32_16x16x32_bf16 v[24:27], v[96:99], v[124:127], v[24:27]
    v_mfma_f32_16x16x32_bf16 v[28:31], v[100:103], v[124:127], v[28:31]
    s_waitcnt lgkmcnt(7)
    v_mfma_f32_16x16x32_bf16 v[32:35], v[128:131], v[96:99], v[32:35]
    v_mfma_f32_16x16x32_bf16 v[36:39], v[128:131], v[100:103], v[36:39]
    s_waitcnt lgkmcnt(6)
    v_mfma_f32_16x16x32_bf16 v[40:43], v[132:135], v[96:99], v[40:43]
    v_mfma_f32_16x16x32_bf16 v[44:47], v[132:135], v[100:103], v[44:47]
    s_waitcnt lgkmcnt(5)
    v_mfma_f32_16x16x32_bf16 v[48:51], v[136:139], v[96:99], v[48:51]
    v_mfma_f32_16x16x32_bf16 v[52:55], v[136:139], v[100:103], v[52:55]
    ds_read_b128 v[120:123], v4 offset:20480
    ds_read_b128 v[124:127], v4 offset:21504
    ds_read_b128 v[128:131], v4 offset:22528
    ds_read_b128 v[132:135], v4 offset:23552
    ds_read_b128 v[136:139], v4 offset:24576
    s_waitcnt lgkmcnt(9)
    v_mfma_f32_16x16x32_bf16 v[56:59], v[140:143], v[96:99], v[56:59]
    v_mfma_f32_16x16x32_bf16 v[60:63], v[140:143], v[100:103], v[60:63]
    s_waitcnt lgkmcnt(8)
    v_mfma_f32_16x16x32_bf16 v[64:67], v[144:147], v[96:99], v[64:67]
    v_mfma_f32_16x16x32_bf16 v[68:71], v[144:147], v[100:103], v[68:71]
    s_waitcnt lgkmcnt(7)
    v_mfma_f32_16x16x32_bf16 v[72:75], v[148:151], v[96:99], v[72:75]
    v_mfma_f32_16x16x32_bf16 v[76:79], v[148:151], v[100:103], v[76:79]
    s_waitcnt lgkmcnt(6)
    v_mfma_f32_16x16x32_bf16 v[80:83], v[152:155], v[96:99], v[80:83]
    v_mfma_f32_16x16x32_bf16 v[84:87], v[152:155], v[100:103], v[84:87]
    s_waitcnt lgkmcnt(5)
    v_mfma_f32_16x16x32_bf16 v[88:91], v[156:159], v[96:99], v[88:91]
    v_mfma_f32_16x16x32_bf16 v[92:95], v[156:159], v[100:103], v[92:95]
    buffer_load_dwordx4 v[96:99], v2, s[28:31], s54 offen offset:0
    buffer_load_dwordx4 v[100:103], v3, s[28:31], s54 offen offset:0
    ds_read_b128 v[140:143], v4 offset:25600
    ds_read_b128 v[144:147], v4 offset:26624
    ds_read_b128 v[148:151], v4 offset:27648
    ds_read_b128 v[152:155], v4 offset:28672
    ds_read_b128 v[156:159], v4 offset:29696
    s_waitcnt vmcnt(5)
    s_waitcnt lgkmcnt(9)
    v_mfma_f32_16x16x32_bf16 v[16:19], v[104:107], v[120:123], v[16:19]
    s_waitcnt vmcnt(4)
    v_mfma_f32_16x16x32_bf16 v[20:23], v[108:111], v[120:123], v[20:23]
    s_waitcnt lgkmcnt(8)
    v_mfma_f32_16x16x32_bf16 v[24:27], v[104:107], v[124:127], v[24:27]
    v_mfma_f32_16x16x32_bf16 v[28:31], v[108:111], v[124:127], v[28:31]
    s_waitcnt lgkmcnt(7)
    v_mfma_f32_16x16x32_bf16 v[32:35], v[128:131], v[104:107], v[32:35]
    v_mfma_f32_16x16x32_bf16 v[36:39], v[128:131], v[108:111], v[36:39]
    s_waitcnt lgkmcnt(6)
    v_mfma_f32_16x16x32_bf16 v[40:43], v[132:135], v[104:107], v[40:43]
    v_mfma_f32_16x16x32_bf16 v[44:47], v[132:135], v[108:111], v[44:47]
    s_waitcnt lgkmcnt(5)
    v_mfma_f32_16x16x32_bf16 v[48:51], v[136:139], v[104:107], v[48:51]
    v_mfma_f32_16x16x32_bf16 v[52:55], v[136:139], v[108:111], v[52:55]
    ds_read_b128 v[120:123], v4 offset:30720
    ds_read_b128 v[124:127], v4 offset:31744
    ds_read_b128 v[128:131], v4 offset:32768
    ds_read_b128 v[132:135], v4 offset:33792
    ds_read_b128 v[136:139], v4 offset:34816
    s_waitcnt lgkmcnt(9)
    v_mfma_f32_16x16x32_bf16 v[56:59], v[140:143], v[104:107], v[56:59]
    v_mfma_f32_16x16x32_bf16 v[60:63], v[140:143], v[108:111], v[60:63]
    s_waitcnt lgkmcnt(8)
    v_mfma_f32_16x16x32_bf16 v[64:67], v[144:147], v[104:107], v[64:67]
    v_mfma_f32_16x16x32_bf16 v[68:71], v[144:147], v[108:111], v[68:71]
    s_waitcnt lgkmcnt(7)
    v_mfma_f32_16x16x32_bf16 v[72:75], v[148:151], v[104:107], v[72:75]
    v_mfma_f32_16x16x32_bf16 v[76:79], v[148:151], v[108:111], v[76:79]
    s_waitcnt lgkmcnt(6)
    v_mfma_f32_16x16x32_bf16 v[80:83], v[152:155], v[104:107], v[80:83]
    v_mfma_f32_16x16x32_bf16 v[84:87], v[152:155], v[108:111], v[84:87]
    s_waitcnt lgkmcnt(5)
    v_mfma_f32_16x16x32_bf16 v[88:91], v[156:159], v[104:107], v[88:91]
    v_mfma_f32_16x16x32_bf16 v[92:95], v[156:159], v[108:111], v[92:95]
    buffer_load_dwordx4 v[104:107], v2, s[28:31], s54 offen offset:1024
    buffer_load_dwordx4 v[108:111], v3, s[28:31], s54 offen offset:1024
    ds_read_b128 v[140:143], v4 offset:35840
    ds_read_b128 v[144:147], v4 offset:36864
    ds_read_b128 v[148:151], v4 offset:37888
    ds_read_b128 v[152:155], v4 offset:38912
    ds_read_b128 v[156:159], v4 offset:39936
    s_waitcnt vmcnt(5)
    s_waitcnt lgkmcnt(9)
    v_mfma_f32_16x16x32_bf16 v[16:19], v[112:115], v[120:123], v[16:19]
    s_waitcnt vmcnt(4)
    v_mfma_f32_16x16x32_bf16 v[20:23], v[116:119], v[120:123], v[20:23]
    s_waitcnt lgkmcnt(8)
    v_mfma_f32_16x16x32_bf16 v[24:27], v[112:115], v[124:127], v[24:27]
    v_mfma_f32_16x16x32_bf16 v[28:31], v[116:119], v[124:127], v[28:31]
    s_waitcnt lgkmcnt(7)
    v_mfma_f32_16x16x32_bf16 v[32:35], v[128:131], v[112:115], v[32:35]
    v_mfma_f32_16x16x32_bf16 v[36:39], v[128:131], v[116:119], v[36:39]
    s_waitcnt lgkmcnt(6)
    v_mfma_f32_16x16x32_bf16 v[40:43], v[132:135], v[112:115], v[40:43]
    v_mfma_f32_16x16x32_bf16 v[44:47], v[132:135], v[116:119], v[44:47]
    s_waitcnt lgkmcnt(5)
    v_mfma_f32_16x16x32_bf16 v[48:51], v[136:139], v[112:115], v[48:51]
    v_mfma_f32_16x16x32_bf16 v[52:55], v[136:139], v[116:119], v[52:55]
    s_waitcnt lgkmcnt(4)
    v_mfma_f32_16x16x32_bf16 v[56:59], v[140:143], v[112:115], v[56:59]
    v_mfma_f32_16x16x32_bf16 v[60:63], v[140:143], v[116:119], v[60:63]
    s_waitcnt lgkmcnt(3)
    v_mfma_f32_16x16x32_bf16 v[64:67], v[144:147], v[112:115], v[64:67]
    v_mfma_f32_16x16x32_bf16 v[68:71], v[144:147], v[116:119], v[68:71]
    s_waitcnt lgkmcnt(2)
    v_mfma_f32_16x16x32_bf16 v[72:75], v[148:151], v[112:115], v[72:75]
    v_mfma_f32_16x16x32_bf16 v[76:79], v[148:151], v[116:119], v[76:79]
    s_waitcnt lgkmcnt(1)
    v_mfma_f32_16x16x32_bf16 v[80:83], v[152:155], v[112:115], v[80:83]
    v_mfma_f32_16x16x32_bf16 v[84:87], v[152:155], v[116:119], v[84:87]
    s_waitcnt lgkmcnt(0)
    v_mfma_f32_16x16x32_bf16 v[88:91], v[156:159], v[112:115], v[88:91]
    v_mfma_f32_16x16x32_bf16 v[92:95], v[156:159], v[116:119], v[92:95]
    s_barrier
    ds_read_b128 v[120:123], v5 offset:0
    ds_read_b128 v[124:127], v5 offset:1024
    ds_read_b128 v[128:131], v5 offset:2048
    ds_read_b128 v[132:135], v5 offset:3072
    ds_read_b128 v[136:139], v5 offset:4096
    buffer_load_dwordx4 v[112:115], v2, s[28:31], s54 offen offset:2048
    buffer_load_dwordx4 v[116:119], v3, s[28:31], s54 offen offset:2048
    ds_read_b128 v[140:143], v5 offset:5120
    ds_read_b128 v[144:147], v5 offset:6144
    ds_read_b128 v[148:151], v5 offset:7168
    ds_read_b128 v[152:155], v5 offset:8192
    ds_read_b128 v[156:159], v5 offset:9216
    s_waitcnt vmcnt(5)
    s_waitcnt lgkmcnt(9)
    v_mfma_f32_16x16x32_bf16 v[16:19], v[96:99], v[120:123], v[16:19]
    s_waitcnt vmcnt(4)
    v_mfma_f32_16x16x32_bf16 v[20:23], v[100:103], v[120:123], v[20:23]
    s_waitcnt lgkmcnt(8)
    v_mfma_f32_16x16x32_bf16 v[24:27], v[96:99], v[124:127], v[24:27]
    v_mfma_f32_16x16x32_bf16 v[28:31], v[100:103], v[124:127], v[28:31]
    s_waitcnt lgkmcnt(7)
    v_mfma_f32_16x16x32_bf16 v[32:35], v[128:131], v[96:99], v[32:35]
    v_mfma_f32_16x16x32_bf16 v[36:39], v[128:131], v[100:103], v[36:39]
    s_waitcnt lgkmcnt(6)
    v_mfma_f32_16x16x32_bf16 v[40:43], v[132:135], v[96:99], v[40:43]
    v_mfma_f32_16x16x32_bf16 v[44:47], v[132:135], v[100:103], v[44:47]
    s_waitcnt lgkmcnt(5)
    v_mfma_f32_16x16x32_bf16 v[48:51], v[136:139], v[96:99], v[48:51]
    v_mfma_f32_16x16x32_bf16 v[52:55], v[136:139], v[100:103], v[52:55]
    ds_read_b128 v[120:123], v5 offset:10240
    ds_read_b128 v[124:127], v5 offset:11264
    ds_read_b128 v[128:131], v5 offset:12288
    ds_read_b128 v[132:135], v5 offset:13312
    ds_read_b128 v[136:139], v5 offset:14336
    s_waitcnt lgkmcnt(9)
    v_mfma_f32_16x16x32_bf16 v[56:59], v[140:143], v[96:99], v[56:59]
    v_mfma_f32_16x16x32_bf16 v[60:63], v[140:143], v[100:103], v[60:63]
    s_waitcnt lgkmcnt(8)
    v_mfma_f32_16x16x32_bf16 v[64:67], v[144:147], v[96:99], v[64:67]
    v_mfma_f32_16x16x32_bf16 v[68:71], v[144:147], v[100:103], v[68:71]
    s_waitcnt lgkmcnt(7)
    v_mfma_f32_16x16x32_bf16 v[72:75], v[148:151], v[96:99], v[72:75]
    v_mfma_f32_16x16x32_bf16 v[76:79], v[148:151], v[100:103], v[76:79]
    s_waitcnt lgkmcnt(6)
    v_mfma_f32_16x16x32_bf16 v[80:83], v[152:155], v[96:99], v[80:83]
    v_mfma_f32_16x16x32_bf16 v[84:87], v[152:155], v[100:103], v[84:87]
    s_waitcnt lgkmcnt(5)
    v_mfma_f32_16x16x32_bf16 v[88:91], v[156:159], v[96:99], v[88:91]
    v_mfma_f32_16x16x32_bf16 v[92:95], v[156:159], v[100:103], v[92:95]
    buffer_load_dwordx4 v[96:99], v2, s[28:31], s54 offen offset:3072
    buffer_load_dwordx4 v[100:103], v3, s[28:31], s54 offen offset:3072
    ds_read_b128 v[140:143], v5 offset:15360
    ds_read_b128 v[144:147], v5 offset:16384
    ds_read_b128 v[148:151], v5 offset:17408
    ds_read_b128 v[152:155], v5 offset:18432
    ds_read_b128 v[156:159], v5 offset:19456
    s_waitcnt vmcnt(5)
    s_waitcnt lgkmcnt(9)
    v_mfma_f32_16x16x32_bf16 v[16:19], v[104:107], v[120:123], v[16:19]
    s_waitcnt vmcnt(4)
    v_mfma_f32_16x16x32_bf16 v[20:23], v[108:111], v[120:123], v[20:23]
    s_waitcnt lgkmcnt(8)
    v_mfma_f32_16x16x32_bf16 v[24:27], v[104:107], v[124:127], v[24:27]
    v_mfma_f32_16x16x32_bf16 v[28:31], v[108:111], v[124:127], v[28:31]
    s_waitcnt lgkmcnt(7)
    v_mfma_f32_16x16x32_bf16 v[32:35], v[128:131], v[104:107], v[32:35]
    v_mfma_f32_16x16x32_bf16 v[36:39], v[128:131], v[108:111], v[36:39]
    s_waitcnt lgkmcnt(6)
    v_mfma_f32_16x16x32_bf16 v[40:43], v[132:135], v[104:107], v[40:43]
    v_mfma_f32_16x16x32_bf16 v[44:47], v[132:135], v[108:111], v[44:47]
    s_waitcnt lgkmcnt(5)
    v_mfma_f32_16x16x32_bf16 v[48:51], v[136:139], v[104:107], v[48:51]
    v_mfma_f32_16x16x32_bf16 v[52:55], v[136:139], v[108:111], v[52:55]
    ds_read_b128 v[120:123], v5 offset:20480
    ds_read_b128 v[124:127], v5 offset:21504
    ds_read_b128 v[128:131], v5 offset:22528
    ds_read_b128 v[132:135], v5 offset:23552
    ds_read_b128 v[136:139], v5 offset:24576
    s_waitcnt lgkmcnt(9)
    v_mfma_f32_16x16x32_bf16 v[56:59], v[140:143], v[104:107], v[56:59]
    v_mfma_f32_16x16x32_bf16 v[60:63], v[140:143], v[108:111], v[60:63]
    s_waitcnt lgkmcnt(8)
    v_mfma_f32_16x16x32_bf16 v[64:67], v[144:147], v[104:107], v[64:67]
    v_mfma_f32_16x16x32_bf16 v[68:71], v[144:147], v[108:111], v[68:71]
    s_waitcnt lgkmcnt(7)
    v_mfma_f32_16x16x32_bf16 v[72:75], v[148:151], v[104:107], v[72:75]
    v_mfma_f32_16x16x32_bf16 v[76:79], v[148:151], v[108:111], v[76:79]
    s_waitcnt lgkmcnt(6)
    v_mfma_f32_16x16x32_bf16 v[80:83], v[152:155], v[104:107], v[80:83]
    v_mfma_f32_16x16x32_bf16 v[84:87], v[152:155], v[108:111], v[84:87]
    s_waitcnt lgkmcnt(5)
    v_mfma_f32_16x16x32_bf16 v[88:91], v[156:159], v[104:107], v[88:91]
    v_mfma_f32_16x16x32_bf16 v[92:95], v[156:159], v[108:111], v[92:95]
    ds_read_b128 v[140:143], v5 offset:25600
    ds_read_b128 v[144:147], v5 offset:26624
    ds_read_b128 v[148:151], v5 offset:27648
    ds_read_b128 v[152:155], v5 offset:28672
    ds_read_b128 v[156:159], v5 offset:29696
    s_waitcnt vmcnt(3)
    s_waitcnt lgkmcnt(9)
    v_mfma_f32_16x16x32_bf16 v[16:19], v[112:115], v[120:123], v[16:19]
    s_waitcnt vmcnt(2)
    v_mfma_f32_16x16x32_bf16 v[20:23], v[116:119], v[120:123], v[20:23]
    s_waitcnt lgkmcnt(8)
    v_mfma_f32_16x16x32_bf16 v[24:27], v[112:115], v[124:127], v[24:27]
    v_mfma_f32_16x16x32_bf16 v[28:31], v[116:119], v[124:127], v[28:31]
    s_waitcnt lgkmcnt(7)
    v_mfma_f32_16x16x32_bf16 v[32:35], v[128:131], v[112:115], v[32:35]
    v_mfma_f32_16x16x32_bf16 v[36:39], v[128:131], v[116:119], v[36:39]
    s_waitcnt lgkmcnt(6)
    v_mfma_f32_16x16x32_bf16 v[40:43], v[132:135], v[112:115], v[40:43]
    v_mfma_f32_16x16x32_bf16 v[44:47], v[132:135], v[116:119], v[44:47]
    s_waitcnt lgkmcnt(5)
    v_mfma_f32_16x16x32_bf16 v[48:51], v[136:139], v[112:115], v[48:51]
    v_mfma_f32_16x16x32_bf16 v[52:55], v[136:139], v[116:119], v[52:55]
    ds_read_b128 v[120:123], v5 offset:30720
    ds_read_b128 v[124:127], v5 offset:31744
    ds_read_b128 v[128:131], v5 offset:32768
    ds_read_b128 v[132:135], v5 offset:33792
    ds_read_b128 v[136:139], v5 offset:34816
    s_waitcnt lgkmcnt(9)
    v_mfma_f32_16x16x32_bf16 v[56:59], v[140:143], v[112:115], v[56:59]
    v_mfma_f32_16x16x32_bf16 v[60:63], v[140:143], v[116:119], v[60:63]
    s_waitcnt lgkmcnt(8)
    v_mfma_f32_16x16x32_bf16 v[64:67], v[144:147], v[112:115], v[64:67]
    v_mfma_f32_16x16x32_bf16 v[68:71], v[144:147], v[116:119], v[68:71]
    s_waitcnt lgkmcnt(7)
    v_mfma_f32_16x16x32_bf16 v[72:75], v[148:151], v[112:115], v[72:75]
    v_mfma_f32_16x16x32_bf16 v[76:79], v[148:151], v[116:119], v[76:79]
    s_waitcnt lgkmcnt(6)
    v_mfma_f32_16x16x32_bf16 v[80:83], v[152:155], v[112:115], v[80:83]
    v_mfma_f32_16x16x32_bf16 v[84:87], v[152:155], v[116:119], v[84:87]
    s_waitcnt lgkmcnt(5)
    v_mfma_f32_16x16x32_bf16 v[88:91], v[156:159], v[112:115], v[88:91]
    v_mfma_f32_16x16x32_bf16 v[92:95], v[156:159], v[116:119], v[92:95]
    ds_read_b128 v[140:143], v5 offset:35840
    ds_read_b128 v[144:147], v5 offset:36864
    ds_read_b128 v[148:151], v5 offset:37888
    ds_read_b128 v[152:155], v5 offset:38912
    ds_read_b128 v[156:159], v5 offset:39936
    s_waitcnt vmcnt(1)
    s_waitcnt lgkmcnt(9)
    v_mfma_f32_16x16x32_bf16 v[16:19], v[96:99], v[120:123], v[16:19]
    s_waitcnt vmcnt(0)
    v_mfma_f32_16x16x32_bf16 v[20:23], v[100:103], v[120:123], v[20:23]
    s_waitcnt lgkmcnt(8)
    v_mfma_f32_16x16x32_bf16 v[24:27], v[96:99], v[124:127], v[24:27]
    v_mfma_f32_16x16x32_bf16 v[28:31], v[100:103], v[124:127], v[28:31]
    s_waitcnt lgkmcnt(7)
    v_mfma_f32_16x16x32_bf16 v[32:35], v[128:131], v[96:99], v[32:35]
    v_mfma_f32_16x16x32_bf16 v[36:39], v[128:131], v[100:103], v[36:39]
    s_waitcnt lgkmcnt(6)
    v_mfma_f32_16x16x32_bf16 v[40:43], v[132:135], v[96:99], v[40:43]
    v_mfma_f32_16x16x32_bf16 v[44:47], v[132:135], v[100:103], v[44:47]
    s_waitcnt lgkmcnt(5)
    v_mfma_f32_16x16x32_bf16 v[48:51], v[136:139], v[96:99], v[48:51]
    v_mfma_f32_16x16x32_bf16 v[52:55], v[136:139], v[100:103], v[52:55]
    s_waitcnt lgkmcnt(4)
    v_mfma_f32_16x16x32_bf16 v[56:59], v[140:143], v[96:99], v[56:59]
    v_mfma_f32_16x16x32_bf16 v[60:63], v[140:143], v[100:103], v[60:63]
    s_waitcnt lgkmcnt(3)
    v_mfma_f32_16x16x32_bf16 v[64:67], v[144:147], v[96:99], v[64:67]
    v_mfma_f32_16x16x32_bf16 v[68:71], v[144:147], v[100:103], v[68:71]
    s_waitcnt lgkmcnt(2)
    v_mfma_f32_16x16x32_bf16 v[72:75], v[148:151], v[96:99], v[72:75]
    v_mfma_f32_16x16x32_bf16 v[76:79], v[148:151], v[100:103], v[76:79]
    s_waitcnt lgkmcnt(1)
    v_mfma_f32_16x16x32_bf16 v[80:83], v[152:155], v[96:99], v[80:83]
    v_mfma_f32_16x16x32_bf16 v[84:87], v[152:155], v[100:103], v[84:87]
    s_waitcnt lgkmcnt(0)
    v_mfma_f32_16x16x32_bf16 v[88:91], v[156:159], v[96:99], v[88:91]
    v_mfma_f32_16x16x32_bf16 v[92:95], v[156:159], v[100:103], v[92:95]
    v_and_b32 v11, 63, v0
    v_lshlrev_b32 v7, 3, v11
    v_lshlrev_b32 v8, 2, v11
    v_lshrrev_b32 v160, 5, v11
    v_lshlrev_b32 v160, 8, v160
    v_and_b32 v161, 15, v11
    v_lshl_add_u32 v160, v161, 4, v160
    v_bfe_u32 v161, v11, 4, 1
    v_lshl_add_u32 v6, v161, 3, v160
    v_mov_b32 v204, 0xc0135761
    v_mov_b32 v205, 0xbdd2d3e8
    s_mul_i32 s61, s33, 2048
    s_add_u32 s61, s61, s58
    v_mov_b32 v12, 0x3f803f80
    v_mov_b32 v13, 0x3f803f80
    v_mov_b32 v14, 0x3f803f80
    v_mov_b32 v15, 0x3f803f80
    s_lshl_b32 s55, s34, 10
    s_add_u32 s55, s55, 81920
    v_add_u32 v9, s55, v1
    v_cvt_pk_bf16_f32 v168, v16, v17
    v_cvt_pk_bf16_f32 v169, v18, v19
    v_lshlrev_b32 v160, 16, v168
    v_and_b32 v161, 0xffff0000, v168
    v_lshlrev_b32 v162, 16, v169
    v_and_b32 v163, 0xffff0000, v169
    v_mul_f32 v174, 0x3fb8aa3b, v160
    v_mul_f32 v175, 0x3fb8aa3b, v161
    v_mul_f32 v176, 0x3fb8aa3b, v162
    v_mul_f32 v177, 0x3fb8aa3b, v163
    v_exp_f32 v174, v174
    v_exp_f32 v175, v175
    v_exp_f32 v176, v176
    v_exp_f32 v177, v177
    v_add_f32 v170, 1.0, v160
    v_add_f32 v171, 1.0, v161
    v_add_f32 v172, 1.0, v162
    v_add_f32 v173, 1.0, v163
    v_cmp_lt_f32 s[64:65], 0, v160
    v_cmp_lt_f32 s[66:67], 0, v161
    v_cmp_lt_f32 s[68:69], 0, v162
    v_cmp_lt_f32 s[70:71], 0, v163
    v_cvt_pk_bf16_f32 v178, v170, v174
    v_cvt_pk_bf16_f32 v179, v171, v175
    v_cvt_pk_bf16_f32 v180, v172, v176
    v_cvt_pk_bf16_f32 v181, v173, v177
    v_lshlrev_b32 v170, 16, v178
    v_lshlrev_b32 v171, 16, v179
    v_lshlrev_b32 v172, 16, v180
    v_lshlrev_b32 v173, 16, v181
    v_and_b32 v174, 0xffff0000, v178
    v_and_b32 v175, 0xffff0000, v179
    v_and_b32 v176, 0xffff0000, v180
    v_and_b32 v177, 0xffff0000, v181
    v_add_f32 v174, 0x358637bd, v174
    v_add_f32 v175, 0x358637bd, v175
    v_add_f32 v176, 0x358637bd, v176
    v_add_f32 v177, 0x358637bd, v177
    v_cndmask_b32 v184, v174, v170, s[64:65]
    v_cndmask_b32 v185, v175, v171, s[66:67]
    v_cndmask_b32 v186, v176, v172, s[68:69]
    v_cndmask_b32 v187, v177, v173, s[70:71]
    v_cvt_pk_bf16_f32 v168, v20, v21
    v_cvt_pk_bf16_f32 v169, v22, v23
    v_lshlrev_b32 v160, 16, v168
    v_and_b32 v161, 0xffff0000, v168
    v_lshlrev_b32 v162, 16, v169
    v_and_b32 v163, 0xffff0000, v169
    v_mul_f32 v174, 0x3fb8aa3b, v160
    v_mul_f32 v175, 0x3fb8aa3b, v161
    v_mul_f32 v176, 0x3fb8aa3b, v162
    v_mul_f32 v177, 0x3fb8aa3b, v163
    v_exp_f32 v174, v174
    v_exp_f32 v175, v175
    v_exp_f32 v176, v176
    v_exp_f32 v177, v177
    v_add_f32 v170, 1.0, v160
    v_add_f32 v171, 1.0, v161
    v_add_f32 v172, 1.0, v162
    v_add_f32 v173, 1.0, v163
    v_cmp_lt_f32 s[64:65], 0, v160
    v_cmp_lt_f32 s[66:67], 0, v161
    v_cmp_lt_f32 s[68:69], 0, v162
    v_cmp_lt_f32 s[70:71], 0, v163
    v_cvt_pk_bf16_f32 v178, v170, v174
    v_cvt_pk_bf16_f32 v179, v171, v175
    v_cvt_pk_bf16_f32 v180, v172, v176
    v_cvt_pk_bf16_f32 v181, v173, v177
    v_lshlrev_b32 v170, 16, v178
    v_lshlrev_b32 v171, 16, v179
    v_lshlrev_b32 v172, 16, v180
    v_lshlrev_b32 v173, 16, v181
    v_and_b32 v174, 0xffff0000, v178
    v_and_b32 v175, 0xffff0000, v179
    v_and_b32 v176, 0xffff0000, v180
    v_and_b32 v177, 0xffff0000, v181
    v_add_f32 v174, 0x358637bd, v174
    v_add_f32 v175, 0x358637bd, v175
    v_add_f32 v176, 0x358637bd, v176
    v_add_f32 v177, 0x358637bd, v177
    v_cndmask_b32 v188, v174, v170, s[64:65]
    v_cndmask_b32 v189, v175, v171, s[66:67]
    v_cndmask_b32 v190, v176, v172, s[68:69]
    v_cndmask_b32 v191, v177, v173, s[70:71]
    v_cvt_pk_bf16_f32 v192, v184, v185
    v_cvt_pk_bf16_f32 v193, v186, v187
    v_cvt_pk_bf16_f32 v194, v188, v189
    v_cvt_pk_bf16_f32 v195, v190, v191
    v_cvt_pk_bf16_f32 v196, v24, v25
    v_cvt_pk_bf16_f32 v197, v26, v27
    v_cvt_pk_bf16_f32 v198, v28, v29
    v_cvt_pk_bf16_f32 v199, v30, v31
    s_nop 1
    v_mfma_f32_16x16x32_bf16 v[120:123], v[192:195], v[196:199], 0
    v_mfma_f32_16x16x32_bf16 v[124:127], v[192:195], v[12:15], 0
    s_nop 6
    ds_write_b128 v9, v[120:123] offset:0
    ds_write_b128 v9, v[124:127] offset:8192
    v_cvt_pk_bf16_f32 v172, v32, v33
    v_cvt_pk_bf16_f32 v173, v34, v35
    v_lshlrev_b32 v160, 16, v172
    v_and_b32 v161, 0xffff0000, v172
    v_lshlrev_b32 v162, 16, v173
    v_and_b32 v163, 0xffff0000, v173
    v_mul_f32 v164, v160, v160
    v_mul_f32 v165, v161, v161
    v_mul_f32 v166, v162, v162
    v_mul_f32 v167, v163, v163
    v_fma_f32 v164, v164, v205, v204
    v_fma_f32 v165, v165, v205, v204
    v_fma_f32 v166, v166, v205, v204
    v_fma_f32 v167, v167, v205, v204
    v_mul_f32 v164, v160, v164
    v_mul_f32 v165, v161, v165
    v_mul_f32 v166, v162, v166
    v_mul_f32 v167, v163, v167
    v_exp_f32 v164, v164
    v_exp_f32 v165, v165
    v_exp_f32 v166, v166
    v_exp_f32 v167, v167
    v_add_f32 v164, 1.0, v164
    v_add_f32 v165, 1.0, v165
    v_add_f32 v166, 1.0, v166
    v_add_f32 v167, 1.0, v167
    v_rcp_f32 v164, v164
    v_rcp_f32 v165, v165
    v_rcp_f32 v166, v166
    v_rcp_f32 v167, v167
    v_mul_f32 v164, v160, v164
    v_mul_f32 v165, v161, v165
    v_mul_f32 v166, v162, v166
    v_mul_f32 v167, v163, v167
    v_cvt_pk_bf16_f32 v172, v164, v165
    v_cvt_pk_bf16_f32 v173, v166, v167
    v_lshlrev_b32 v164, 16, v172
    v_and_b32 v165, 0xffff0000, v172
    v_lshlrev_b32 v166, 16, v173
    v_and_b32 v167, 0xffff0000, v173
    v_cvt_pk_bf16_f32 v174, v40, v41
    v_cvt_pk_bf16_f32 v175, v42, v43
    v_lshlrev_b32 v168, 16, v174
    v_and_b32 v169, 0xffff0000, v174
    v_lshlrev_b32 v170, 16, v175
    v_and_b32 v171, 0xffff0000, v175
    v_mul_f32 v164, v164, v168
    v_mul_f32 v165, v165, v169
    v_mul_f32 v166, v166, v170
    v_mul_f32 v167, v167, v171
    v_cvt_pk_bf16_f32 v176, v164, v165
    v_cvt_pk_bf16_f32 v177, v166, v167
    s_add_u32 s55, s61, 0xffffe000
    buffer_store_dwordx2 v[176:177], v6, s[28:31], s55 offen sc1
    v_cvt_pk_bf16_f32 v172, v36, v37
    v_cvt_pk_bf16_f32 v173, v38, v39
    v_lshlrev_b32 v160, 16, v172
    v_and_b32 v161, 0xffff0000, v172
    v_lshlrev_b32 v162, 16, v173
    v_and_b32 v163, 0xffff0000, v173
    v_mul_f32 v164, v160, v160
    v_mul_f32 v165, v161, v161
    v_mul_f32 v166, v162, v162
    v_mul_f32 v167, v163, v163
    v_fma_f32 v164, v164, v205, v204
    v_fma_f32 v165, v165, v205, v204
    v_fma_f32 v166, v166, v205, v204
    v_fma_f32 v167, v167, v205, v204
    v_mul_f32 v164, v160, v164
    v_mul_f32 v165, v161, v165
    v_mul_f32 v166, v162, v166
    v_mul_f32 v167, v163, v167
    v_exp_f32 v164, v164
    v_exp_f32 v165, v165
    v_exp_f32 v166, v166
    v_exp_f32 v167, v167
    v_add_f32 v164, 1.0, v164
    v_add_f32 v165, 1.0, v165
    v_add_f32 v166, 1.0, v166
    v_add_f32 v167, 1.0, v167
    v_rcp_f32 v164, v164
    v_rcp_f32 v165, v165
    v_rcp_f32 v166, v166
    v_rcp_f32 v167, v167
    v_mul_f32 v164, v160, v164
    v_mul_f32 v165, v161, v165
    v_mul_f32 v166, v162, v166
    v_mul_f32 v167, v163, v167
    v_cvt_pk_bf16_f32 v172, v164, v165
    v_cvt_pk_bf16_f32 v173, v166, v167
    v_lshlrev_b32 v164, 16, v172
    v_and_b32 v165, 0xffff0000, v172
    v_lshlrev_b32 v166, 16, v173
    v_and_b32 v167, 0xffff0000, v173
    v_cvt_pk_bf16_f32 v174, v44, v45
    v_cvt_pk_bf16_f32 v175, v46, v47
    v_lshlrev_b32 v168, 16, v174
    v_and_b32 v169, 0xffff0000, v174
    v_lshlrev_b32 v170, 16, v175
    v_and_b32 v171, 0xffff0000, v175
    v_mul_f32 v164, v164, v168
    v_mul_f32 v165, v165, v169
    v_mul_f32 v166, v166, v170
    v_mul_f32 v167, v167, v171
    v_cvt_pk_bf16_f32 v176, v164, v165
    v_cvt_pk_bf16_f32 v177, v166, v167
    s_add_u32 s55, s61, 0xc000
    buffer_store_dwordx2 v[176:177], v6, s[28:31], s55 offen sc1
    v_cvt_pk_bf16_f32 v172, v48, v49
    v_cvt_pk_bf16_f32 v173, v50, v51
    v_lshlrev_b32 v160, 16, v172
    v_and_b32 v161, 0xffff0000, v172
    v_lshlrev_b32 v162, 16, v173
    v_and_b32 v163, 0xffff0000, v173
    v_mul_f32 v164, v160, v160
    v_mul_f32 v165, v161, v161
    v_mul_f32 v166, v162, v162
    v_mul_f32 v167, v163, v163
    v_fma_f32 v164, v164, v205, v204
    v_fma_f32 v165, v165, v205, v204
    v_fma_f32 v166, v166, v205, v204
    v_fma_f32 v167, v167, v205, v204
    v_mul_f32 v164, v160, v164
    v_mul_f32 v165, v161, v165
    v_mul_f32 v166, v162, v166
    v_mul_f32 v167, v163, v167
    v_exp_f32 v164, v164
    v_exp_f32 v165, v165
    v_exp_f32 v166, v166
    v_exp_f32 v167, v167
    v_add_f32 v164, 1.0, v164
    v_add_f32 v165, 1.0, v165
    v_add_f32 v166, 1.0, v166
    v_add_f32 v167, 1.0, v167
    v_rcp_f32 v164, v164
    v_rcp_f32 v165, v165
    v_rcp_f32 v166, v166
    v_rcp_f32 v167, v167
    v_mul_f32 v164, v160, v164
    v_mul_f32 v165, v161, v165
    v_mul_f32 v166, v162, v166
    v_mul_f32 v167, v163, v167
    v_cvt_pk_bf16_f32 v172, v164, v165
    v_cvt_pk_bf16_f32 v173, v166, v167
    v_lshlrev_b32 v164, 16, v172
    v_and_b32 v165, 0xffff0000, v172
    v_lshlrev_b32 v166, 16, v173
    v_and_b32 v167, 0xffff0000, v173
    v_cvt_pk_bf16_f32 v174, v56, v57
    v_cvt_pk_bf16_f32 v175, v58, v59
    v_lshlrev_b32 v168, 16, v174
    v_and_b32 v169, 0xffff0000, v174
    v_lshlrev_b32 v170, 16, v175
    v_and_b32 v171, 0xffff0000, v175
    v_mul_f32 v164, v164, v168
    v_mul_f32 v165, v165, v169
    v_mul_f32 v166, v166, v170
    v_mul_f32 v167, v167, v171
    v_cvt_pk_bf16_f32 v176, v164, v165
    v_cvt_pk_bf16_f32 v177, v166, v167
    s_add_u32 s55, s61, 0xffffe200
    buffer_store_dwordx2 v[176:177], v6, s[28:31], s55 offen sc1
    v_cvt_pk_bf16_f32 v172, v52, v53
    v_cvt_pk_bf16_f32 v173, v54, v55
    v_lshlrev_b32 v160, 16, v172
    v_and_b32 v161, 0xffff0000, v172
    v_lshlrev_b32 v162, 16, v173
    v_and_b32 v163, 0xffff0000, v173
    v_mul_f32 v164, v160, v160
    v_mul_f32 v165, v161, v161
    v_mul_f32 v166, v162, v162
    v_mul_f32 v167, v163, v163
    v_fma_f32 v164, v164, v205, v204
    v_fma_f32 v165, v165, v205, v204
    v_fma_f32 v166, v166, v205, v204
    v_fma_f32 v167, v167, v205, v204
    v_mul_f32 v164, v160, v164
    v_mul_f32 v165, v161, v165
    v_mul_f32 v166, v162, v166
    v_mul_f32 v167, v163, v167
    v_exp_f32 v164, v164
    v_exp_f32 v165, v165
    v_exp_f32 v166, v166
    v_exp_f32 v167, v167
    v_add_f32 v164, 1.0, v164
    v_add_f32 v165, 1.0, v165
    v_add_f32 v166, 1.0, v166
    v_add_f32 v167, 1.0, v167
    v_rcp_f32 v164, v164
    v_rcp_f32 v165, v165
    v_rcp_f32 v166, v166
    v_rcp_f32 v167, v167
    v_mul_f32 v164, v160, v164
    v_mul_f32 v165, v161, v165
    v_mul_f32 v166, v162, v166
    v_mul_f32 v167, v163, v167
    v_cvt_pk_bf16_f32 v172, v164, v165
    v_cvt_pk_bf16_f32 v173, v166, v167
    v_lshlrev_b32 v164, 16, v172
    v_and_b32 v165, 0xffff0000, v172
    v_lshlrev_b32 v166, 16, v173
    v_and_b32 v167, 0xffff0000, v173
    v_cvt_pk_bf16_f32 v174, v60, v61
    v_cvt_pk_bf16_f32 v175, v62, v63
    v_lshlrev_b32 v168, 16, v174
    v_and_b32 v169, 0xffff0000, v174
    v_lshlrev_b32 v170, 16, v175
    v_and_b32 v171, 0xffff0000, v175
    v_mul_f32 v164, v164, v168
    v_mul_f32 v165, v165, v169
    v_mul_f32 v166, v166, v170
    v_mul_f32 v167, v167, v171
    v_cvt_pk_bf16_f32 v176, v164, v165
    v_cvt_pk_bf16_f32 v177, v166, v167
    s_add_u32 s55, s61, 0xc200
    buffer_store_dwordx2 v[176:177], v6, s[28:31], s55 offen sc1
    v_cvt_pk_bf16_f32 v172, v64, v65
    v_cvt_pk_bf16_f32 v173, v66, v67
    v_lshlrev_b32 v160, 16, v172
    v_and_b32 v161, 0xffff0000, v172
    v_lshlrev_b32 v162, 16, v173
    v_and_b32 v163, 0xffff0000, v173
    v_mul_f32 v164, v160, v160
    v_mul_f32 v165, v161, v161
    v_mul_f32 v166, v162, v162
    v_mul_f32 v167, v163, v163
    v_fma_f32 v164, v164, v205, v204
    v_fma_f32 v165, v165, v205, v204
    v_fma_f32 v166, v166, v205, v204
    v_fma_f32 v167, v167, v205, v204
    v_mul_f32 v164, v160, v164
    v_mul_f32 v165, v161, v165
    v_mul_f32 v166, v162, v166
    v_mul_f32 v167, v163, v167
    v_exp_f32 v164, v164
    v_exp_f32 v165, v165
    v_exp_f32 v166, v166
    v_exp_f32 v167, v167
    v_add_f32 v164, 1.0, v164
    v_add_f32 v165, 1.0, v165
    v_add_f32 v166, 1.0, v166
    v_add_f32 v167, 1.0, v167
    v_rcp_f32 v164, v164
    v_rcp_f32 v165, v165
    v_rcp_f32 v166, v166
    v_rcp_f32 v167, v167
    v_mul_f32 v164, v160, v164
    v_mul_f32 v165, v161, v165
    v_mul_f32 v166, v162, v166
    v_mul_f32 v167, v163, v167
    v_cvt_pk_bf16_f32 v172, v164, v165
    v_cvt_pk_bf16_f32 v173, v166, v167
    v_lshlrev_b32 v164, 16, v172
    v_and_b32 v165, 0xffff0000, v172
    v_lshlrev_b32 v166, 16, v173
    v_and_b32 v167, 0xffff0000, v173
    v_cvt_pk_bf16_f32 v174, v72, v73
    v_cvt_pk_bf16_f32 v175, v74, v75
    v_lshlrev_b32 v168, 16, v174
    v_and_b32 v169, 0xffff0000, v174
    v_lshlrev_b32 v170, 16, v175
    v_and_b32 v171, 0xffff0000, v175
    v_mul_f32 v164, v164, v168
    v_mul_f32 v165, v165, v169
    v_mul_f32 v166, v166, v170
    v_mul_f32 v167, v167, v171
    v_cvt_pk_bf16_f32 v176, v164, v165
    v_cvt_pk_bf16_f32 v177, v166, v167
    s_add_u32 s55, s61, 0xffffe400
    buffer_store_dwordx2 v[176:177], v6, s[28:31], s55 offen sc1
    v_cvt_pk_bf16_f32 v172, v68, v69
    v_cvt_pk_bf16_f32 v173, v70, v71
    v_lshlrev_b32 v160, 16, v172
    v_and_b32 v161, 0xffff0000, v172
    v_lshlrev_b32 v162, 16, v173
    v_and_b32 v163, 0xffff0000, v173
    v_mul_f32 v164, v160, v160
    v_mul_f32 v165, v161, v161
    v_mul_f32 v166, v162, v162
    v_mul_f32 v167, v163, v163
    v_fma_f32 v164, v164, v205, v204
    v_fma_f32 v165, v165, v205, v204
    v_fma_f32 v166, v166, v205, v204
    v_fma_f32 v167, v167, v205, v204
    v_mul_f32 v164, v160, v164
    v_mul_f32 v165, v161, v165
    v_mul_f32 v166, v162, v166
    v_mul_f32 v167, v163, v167
    v_exp_f32 v164, v164
    v_exp_f32 v165, v165
    v_exp_f32 v166, v166
    v_exp_f32 v167, v167
    v_add_f32 v164, 1.0, v164
    v_add_f32 v165, 1.0, v165
    v_add_f32 v166, 1.0, v166
    v_add_f32 v167, 1.0, v167
    v_rcp_f32 v164, v164
    v_rcp_f32 v165, v165
    v_rcp_f32 v166, v166
    v_rcp_f32 v167, v167
    v_mul_f32 v164, v160, v164
    v_mul_f32 v165, v161, v165
    v_mul_f32 v166, v162, v166
    v_mul_f32 v167, v163, v167
    v_cvt_pk_bf16_f32 v172, v164, v165
    v_cvt_pk_bf16_f32 v173, v166, v167
    v_lshlrev_b32 v164, 16, v172
    v_and_b32 v165, 0xffff0000, v172
    v_lshlrev_b32 v166, 16, v173
    v_and_b32 v167, 0xffff0000, v173
    v_cvt_pk_bf16_f32 v174, v76, v77
    v_cvt_pk_bf16_f32 v175, v78, v79
    v_lshlrev_b32 v168, 16, v174
    v_and_b32 v169, 0xffff0000, v174
    v_lshlrev_b32 v170, 16, v175
    v_and_b32 v171, 0xffff0000, v175
    v_mul_f32 v164, v164, v168
    v_mul_f32 v165, v165, v169
    v_mul_f32 v166, v166, v170
    v_mul_f32 v167, v167, v171
    v_cvt_pk_bf16_f32 v176, v164, v165
    v_cvt_pk_bf16_f32 v177, v166, v167
    s_add_u32 s55, s61, 0xc400
    buffer_store_dwordx2 v[176:177], v6, s[28:31], s55 offen sc1
    v_cvt_pk_bf16_f32 v172, v80, v81
    v_cvt_pk_bf16_f32 v173, v82, v83
    v_lshlrev_b32 v160, 16, v172
    v_and_b32 v161, 0xffff0000, v172
    v_lshlrev_b32 v162, 16, v173
    v_and_b32 v163, 0xffff0000, v173
    v_mul_f32 v164, v160, v160
    v_mul_f32 v165, v161, v161
    v_mul_f32 v166, v162, v162
    v_mul_f32 v167, v163, v163
    v_fma_f32 v164, v164, v205, v204
    v_fma_f32 v165, v165, v205, v204
    v_fma_f32 v166, v166, v205, v204
    v_fma_f32 v167, v167, v205, v204
    v_mul_f32 v164, v160, v164
    v_mul_f32 v165, v161, v165
    v_mul_f32 v166, v162, v166
    v_mul_f32 v167, v163, v167
    v_exp_f32 v164, v164
    v_exp_f32 v165, v165
    v_exp_f32 v166, v166
    v_exp_f32 v167, v167
    v_add_f32 v164, 1.0, v164
    v_add_f32 v165, 1.0, v165
    v_add_f32 v166, 1.0, v166
    v_add_f32 v167, 1.0, v167
    v_rcp_f32 v164, v164
    v_rcp_f32 v165, v165
    v_rcp_f32 v166, v166
    v_rcp_f32 v167, v167
    v_mul_f32 v164, v160, v164
    v_mul_f32 v165, v161, v165
    v_mul_f32 v166, v162, v166
    v_mul_f32 v167, v163, v167
    v_cvt_pk_bf16_f32 v172, v164, v165
    v_cvt_pk_bf16_f32 v173, v166, v167
    v_lshlrev_b32 v164, 16, v172
    v_and_b32 v165, 0xffff0000, v172
    v_lshlrev_b32 v166, 16, v173
    v_and_b32 v167, 0xffff0000, v173
    v_cvt_pk_bf16_f32 v174, v88, v89
    v_cvt_pk_bf16_f32 v175, v90, v91
    v_lshlrev_b32 v168, 16, v174
    v_and_b32 v169, 0xffff0000, v174
    v_lshlrev_b32 v170, 16, v175
    v_and_b32 v171, 0xffff0000, v175
    v_mul_f32 v164, v164, v168
    v_mul_f32 v165, v165, v169
    v_mul_f32 v166, v166, v170
    v_mul_f32 v167, v167, v171
    v_cvt_pk_bf16_f32 v176, v164, v165
    v_cvt_pk_bf16_f32 v177, v166, v167
    s_add_u32 s55, s61, 0xffffe600
    buffer_store_dwordx2 v[176:177], v6, s[28:31], s55 offen sc1
    v_cvt_pk_bf16_f32 v172, v84, v85
    v_cvt_pk_bf16_f32 v173, v86, v87
    v_lshlrev_b32 v160, 16, v172
    v_and_b32 v161, 0xffff0000, v172
    v_lshlrev_b32 v162, 16, v173
    v_and_b32 v163, 0xffff0000, v173
    v_mul_f32 v164, v160, v160
    v_mul_f32 v165, v161, v161
    v_mul_f32 v166, v162, v162
    v_mul_f32 v167, v163, v163
    v_fma_f32 v164, v164, v205, v204
    v_fma_f32 v165, v165, v205, v204
    v_fma_f32 v166, v166, v205, v204
    v_fma_f32 v167, v167, v205, v204
    v_mul_f32 v164, v160, v164
    v_mul_f32 v165, v161, v165
    v_mul_f32 v166, v162, v166
    v_mul_f32 v167, v163, v167
    v_exp_f32 v164, v164
    v_exp_f32 v165, v165
    v_exp_f32 v166, v166
    v_exp_f32 v167, v167
    v_add_f32 v164, 1.0, v164
    v_add_f32 v165, 1.0, v165
    v_add_f32 v166, 1.0, v166
    v_add_f32 v167, 1.0, v167
    v_rcp_f32 v164, v164
    v_rcp_f32 v165, v165
    v_rcp_f32 v166, v166
    v_rcp_f32 v167, v167
    v_mul_f32 v164, v160, v164
    v_mul_f32 v165, v161, v165
    v_mul_f32 v166, v162, v166
    v_mul_f32 v167, v163, v167
    v_cvt_pk_bf16_f32 v172, v164, v165
    v_cvt_pk_bf16_f32 v173, v166, v167
    v_lshlrev_b32 v164, 16, v172
    v_and_b32 v165, 0xffff0000, v172
    v_lshlrev_b32 v166, 16, v173
    v_and_b32 v167, 0xffff0000, v173
    v_cvt_pk_bf16_f32 v174, v92, v93
    v_cvt_pk_bf16_f32 v175, v94, v95
    v_lshlrev_b32 v168, 16, v174
    v_and_b32 v169, 0xffff0000, v174
    v_lshlrev_b32 v170, 16, v175
    v_and_b32 v171, 0xffff0000, v175
    v_mul_f32 v164, v164, v168
    v_mul_f32 v165, v165, v169
    v_mul_f32 v166, v166, v170
    v_mul_f32 v167, v167, v171
    v_cvt_pk_bf16_f32 v176, v164, v165
    v_cvt_pk_bf16_f32 v177, v166, v167
    s_add_u32 s55, s61, 0xc600
    buffer_store_dwordx2 v[176:177], v6, s[28:31], s55 offen sc1
    s_waitcnt lgkmcnt(0)
    s_barrier
    s_mul_i32 s60, s33, 2048
    s_add_u32 s60, s60, 0x1300000
    s_lshl_b32 s55, s34, 13
    s_add_u32 s55, s55, 81920
    v_add_u32 v10, s55, v1
    s_cmp_ge_u32 s34, 2
    s_cbranch_scc1 K1_K1F4_RED_SKIP
    ds_read_b128 v[160:163], v10 offset:0
    ds_read_b128 v[164:167], v10 offset:1024
    ds_read_b128 v[168:171], v10 offset:2048
    ds_read_b128 v[172:175], v10 offset:3072
    ds_read_b128 v[176:179], v10 offset:4096
    ds_read_b128 v[180:183], v10 offset:5120
    ds_read_b128 v[184:187], v10 offset:6144
    ds_read_b128 v[188:191], v10 offset:7168
    s_waitcnt lgkmcnt(6)
    v_add_f32 v160, v160, v164
    s_waitcnt lgkmcnt(4)
    v_add_f32 v168, v168, v172
    s_waitcnt lgkmcnt(2)
    v_add_f32 v176, v176, v180
    s_waitcnt lgkmcnt(0)
    v_add_f32 v184, v184, v188
    v_add_f32 v161, v161, v165
    v_add_f32 v169, v169, v173
    v_add_f32 v177, v177, v181
    v_add_f32 v185, v185, v189
    v_add_f32 v162, v162, v166
    v_add_f32 v170, v170, v174
    v_add_f32 v178, v178, v182
    v_add_f32 v186, v186, v190
    v_add_f32 v163, v163, v167
    v_add_f32 v171, v171, v175
    v_add_f32 v179, v179, v183
    v_add_f32 v187, v187, v191
    v_add_f32 v160, v160, v168
    v_add_f32 v176, v176, v184
    v_add_f32 v161, v161, v169
    v_add_f32 v177, v177, v185
    v_add_f32 v162, v162, v170
    v_add_f32 v178, v178, v186
    v_add_f32 v163, v163, v171
    v_add_f32 v179, v179, v187
    v_add_f32 v160, v160, v176
    v_add_f32 v161, v161, v177
    v_add_f32 v162, v162, v178
    v_add_f32 v163, v163, v179
    s_lshl_b32 s55, s34, 10
    s_add_u32 s55, s55, s60
    buffer_atomic_add_f32 v160, v8, s[28:31], s55 offen offset:0
    buffer_atomic_add_f32 v161, v8, s[28:31], s55 offen offset:256
    buffer_atomic_add_f32 v162, v8, s[28:31], s55 offen offset:512
    buffer_atomic_add_f32 v163, v8, s[28:31], s55 offen offset:768
K1_K1F4_RED_SKIP:
    s_branch K1_END
K1_END:
    s_endpgm
.text
.globl k2_gemm_kernel
.p2align 8
.type k2_gemm_kernel,@function
k2_gemm_kernel:
    s_cmp_ge_u32 s2, 256
    s_cbranch_scc1 K2_END
    s_load_dwordx8 s[8:15], s[0:1], 0
    s_load_dwordx8 s[16:23], s[0:1], 32
    s_load_dwordx4 s[24:27], s[0:1], 64
    s_waitcnt lgkmcnt(0)
    s_mov_b32 s28, s26
    s_and_b32 s29, s27, 0xffff
    s_mov_b32 s30, 0x1400000
    s_mov_b32 s31, 0x00020000
    s_mov_b32 s60, s8
    s_and_b32 s61, s9, 0xffff
    s_mov_b32 s62, 0x200000
    s_mov_b32 s63, 0x00020000
    s_mov_b32 s64, s22
    s_and_b32 s65, s23, 0xffff
    s_mov_b32 s66, 0x200000
    s_mov_b32 s67, 0x00020000
    s_and_b32 s32, s2, 31
    s_lshr_b32 s33, s2, 5
    v_lshrrev_b32 v7, 6, v0
    s_nop 0
    v_readfirstlane_b32 s34, v7
    v_and_b32 v7, 63, v0
    v_lshlrev_b32 v1, 4, v7
    v_lshlrev_b32 v2, 3, v7
    v_lshlrev_b32 v3, 2, v7
    s_mul_i32 s53, s34, 14336
    s_mul_i32 s54, s33, 229376
    s_add_u32 s54, s54, s53
    s_add_u32 s36, s54, 0x700000
    s_add_u32 s37, s54, 0x70e000
    s_add_u32 s38, s54, 0x71c000
    s_add_u32 s39, s54, 0x72a000
    s_mul_i32 s54, s32, 229376
    s_add_u32 s54, s54, s53
    s_add_u32 s40, s54, 0xc00000
    s_add_u32 s41, s54, 0xc0e000
    s_add_u32 s42, s54, 0xc1c000
    s_add_u32 s43, s54, 0xc2a000
    s_lshl_b32 s53, s34, 12
    s_lshl_b32 s54, s33, 16
    s_add_u32 s54, s54, s53
    s_add_u32 s44, s54, 0x900000
    s_add_u32 s45, s54, 0x904000
    s_add_u32 s46, s54, 0x908000
    s_add_u32 s47, s54, 0x90c000
    s_lshl_b32 s54, s32, 16
    s_add_u32 s54, s54, s53
    s_add_u32 s48, s54, 0xa00000
    s_add_u32 s49, s54, 0xa04000
    s_add_u32 s50, s54, 0xa08000
    s_add_u32 s51, s54, 0xa0c000
    s_lshl_b32 s52, s34, 14
    s_add_u32 s52, s52, 0x1300000
    v_and_b32 v7, 63, v0
    v_and_b32 v4, 15, v7
    v_lshlrev_b32 v4, 10, v4
    v_lshrrev_b32 v7, 4, v7
    v_lshl_add_u32 v4, v7, 3, v4
    s_lshl_b32 s57, s32, 16
    s_lshl_b32 s53, s34, 14
    s_add_u32 s57, s57, s53
    s_lshl_b32 s53, s33, 7
    s_add_u32 s57, s57, s53
    buffer_load_dwordx2 v[8:9], v4, s[60:63], s57 offen offset:0
    buffer_load_dwordx2 v[10:11], v4, s[60:63], s57 offen offset:32
    buffer_load_dwordx2 v[12:13], v4, s[60:63], s57 offen offset:64
    buffer_load_dwordx2 v[14:15], v4, s[60:63], s57 offen offset:96
    buffer_load_dword v180, v3, s[28:31], s52 offen offset:0
    buffer_load_dword v181, v3, s[28:31], s52 offen offset:256
    buffer_load_dword v182, v3, s[28:31], s52 offen offset:512
    buffer_load_dword v183, v3, s[28:31], s52 offen offset:768
    buffer_load_dword v184, v3, s[28:31], s52 offen offset:1024
    buffer_load_dword v185, v3, s[28:31], s52 offen offset:1280
    buffer_load_dword v186, v3, s[28:31], s52 offen offset:1536
    buffer_load_dword v187, v3, s[28:31], s52 offen offset:1792
    buffer_load_dword v188, v3, s[28:31], s52 offen offset:2048
    buffer_load_dword v189, v3, s[28:31], s52 offen offset:2304
    buffer_load_dword v190, v3, s[28:31], s52 offen offset:2560
    buffer_load_dword v191, v3, s[28:31], s52 offen offset:2816
    buffer_load_dword v192, v3, s[28:31], s52 offen offset:3072
    buffer_load_dword v193, v3, s[28:31], s52 offen offset:3328
    buffer_load_dword v194, v3, s[28:31], s52 offen offset:3584
    buffer_load_dword v195, v3, s[28:31], s52 offen offset:3840
    s_add_u32 s52, s52, 4096
    buffer_load_dword v196, v3, s[28:31], s52 offen offset:0
    buffer_load_dword v197, v3, s[28:31], s52 offen offset:256
    buffer_load_dword v198, v3, s[28:31], s52 offen offset:512
    buffer_load_dword v199, v3, s[28:31], s52 offen offset:768
    buffer_load_dword v200, v3, s[28:31], s52 offen offset:1024
    buffer_load_dword v201, v3, s[28:31], s52 offen offset:1280
    buffer_load_dword v202, v3, s[28:31], s52 offen offset:1536
    buffer_load_dword v203, v3, s[28:31], s52 offen offset:1792
    buffer_load_dword v204, v3, s[28:31], s52 offen offset:2048
    buffer_load_dword v205, v3, s[28:31], s52 offen offset:2304
    buffer_load_dword v206, v3, s[28:31], s52 offen offset:2560
    buffer_load_dword v207, v3, s[28:31], s52 offen offset:2816
    buffer_load_dword v208, v3, s[28:31], s52 offen offset:3072
    buffer_load_dword v209, v3, s[28:31], s52 offen offset:3328
    buffer_load_dword v210, v3, s[28:31], s52 offen offset:3584
    buffer_load_dword v211, v3, s[28:31], s52 offen offset:3840
    s_add_u32 s52, s52, 4096
    buffer_load_dword v212, v3, s[28:31], s52 offen offset:0
    buffer_load_dword v213, v3, s[28:31], s52 offen offset:256
    buffer_load_dword v214, v3, s[28:31], s52 offen offset:512
    buffer_load_dword v215, v3, s[28:31], s52 offen offset:768
    buffer_load_dword v216, v3, s[28:31], s52 offen offset:1024
    buffer_load_dword v217, v3, s[28:31], s52 offen offset:1280
    buffer_load_dword v218, v3, s[28:31], s52 offen offset:1536
    buffer_load_dword v219, v3, s[28:31], s52 offen offset:1792
    buffer_load_dword v220, v3, s[28:31], s52 offen offset:2048
    buffer_load_dword v221, v3, s[28:31], s52 offen offset:2304
    buffer_load_dword v222, v3, s[28:31], s52 offen offset:2560
    buffer_load_dword v223, v3, s[28:31], s52 offen offset:2816
    buffer_load_dword v224, v3, s[28:31], s52 offen offset:3072
    buffer_load_dword v225, v3, s[28:31], s52 offen offset:3328
    buffer_load_dword v226, v3, s[28:31], s52 offen offset:3584
    buffer_load_dword v227, v3, s[28:31], s52 offen offset:3840
    s_add_u32 s52, s52, 4096
    buffer_load_dword v228, v3, s[28:31], s52 offen offset:0
    buffer_load_dword v229, v3, s[28:31], s52 offen offset:256
    buffer_load_dword v230, v3, s[28:31], s52 offen offset:512
    buffer_load_dword v231, v3, s[28:31], s52 offen offset:768
    buffer_load_dword v232, v3, s[28:31], s52 offen offset:1024
    buffer_load_dword v233, v3, s[28:31], s52 offen offset:1280
    buffer_load_dword v234, v3, s[28:31], s52 offen offset:1536
    buffer_load_dword v235, v3, s[28:31], s52 offen offset:1792
    buffer_load_dword v236, v3, s[28:31], s52 offen offset:2048
    buffer_load_dword v237, v3, s[28:31], s52 offen offset:2304
    buffer_load_dword v238, v3, s[28:31], s52 offen offset:2560
    buffer_load_dword v239, v3, s[28:31], s52 offen offset:2816
    s_waitcnt vmcnt(63)
    buffer_load_dword v240, v3, s[28:31], s52 offen offset:3072
    s_waitcnt vmcnt(63)
    buffer_load_dword v241, v3, s[28:31], s52 offen offset:3328
    s_waitcnt vmcnt(63)
    buffer_load_dword v242, v3, s[28:31], s52 offen offset:3584
    s_waitcnt vmcnt(63)
    buffer_load_dword v243, v3, s[28:31], s52 offen offset:3840
    s_waitcnt vmcnt(63)
    buffer_load_dwordx2 a[128:129], v2, s[28:31], s48 offen offset:0
    s_waitcnt vmcnt(63)
    buffer_load_dwordx2 a[130:131], v2, s[28:31], s48 offen offset:512
    s_waitcnt vmcnt(63)
    buffer_load_dwordx2 a[132:133], v2, s[28:31], s48 offen offset:1024
    s_waitcnt vmcnt(63)
    buffer_load_dwordx2 a[134:135], v2, s[28:31], s48 offen offset:1536
    s_waitcnt vmcnt(63)
    buffer_load_dwordx2 a[136:137], v2, s[28:31], s48 offen offset:2048
    s_waitcnt vmcnt(63)
    buffer_load_dwordx2 a[138:139], v2, s[28:31], s48 offen offset:2560
    s_waitcnt vmcnt(63)
    buffer_load_dwordx2 a[140:141], v2, s[28:31], s48 offen offset:3072
    s_waitcnt vmcnt(63)
    buffer_load_dwordx2 a[142:143], v2, s[28:31], s48 offen offset:3584
    s_waitcnt vmcnt(63)
    buffer_load_dwordx2 a[144:145], v2, s[28:31], s49 offen offset:0
    s_waitcnt vmcnt(63)
    buffer_load_dwordx2 a[146:147], v2, s[28:31], s49 offen offset:512
    s_waitcnt vmcnt(63)
    buffer_load_dwordx2 a[148:149], v2, s[28:31], s49 offen offset:1024
    s_waitcnt vmcnt(63)
    buffer_load_dwordx2 a[150:151], v2, s[28:31], s49 offen offset:1536
    s_waitcnt vmcnt(63)
    buffer_load_dwordx2 a[152:153], v2, s[28:31], s49 offen offset:2048
    s_waitcnt vmcnt(63)
    buffer_load_dwordx2 a[154:155], v2, s[28:31], s49 offen offset:2560
    s_waitcnt vmcnt(63)
    buffer_load_dwordx2 a[156:157], v2, s[28:31], s49 offen offset:3072
    s_waitcnt vmcnt(63)
    buffer_load_dwordx2 a[158:159], v2, s[28:31], s49 offen offset:3584
    s_waitcnt vmcnt(63)
    buffer_load_dwordx2 a[160:161], v2, s[28:31], s50 offen offset:0
    s_waitcnt vmcnt(63)
    buffer_load_dwordx2 a[162:163], v2, s[28:31], s50 offen offset:512
    s_waitcnt vmcnt(63)
    buffer_load_dwordx2 a[164:165], v2, s[28:31], s50 offen offset:1024
    s_waitcnt vmcnt(63)
    buffer_load_dwordx2 a[166:167], v2, s[28:31], s50 offen offset:1536
    s_waitcnt vmcnt(63)
    buffer_load_dwordx2 a[168:169], v2, s[28:31], s50 offen offset:2048
    s_waitcnt vmcnt(63)
    buffer_load_dwordx2 a[170:171], v2, s[28:31], s50 offen offset:2560
    s_waitcnt vmcnt(63)
    buffer_load_dwordx2 a[172:173], v2, s[28:31], s50 offen offset:3072
    s_waitcnt vmcnt(63)
    buffer_load_dwordx2 a[174:175], v2, s[28:31], s50 offen offset:3584
    s_waitcnt vmcnt(63)
    buffer_load_dwordx2 a[176:177], v2, s[28:31], s51 offen offset:0
    s_waitcnt vmcnt(63)
    buffer_load_dwordx2 a[178:179], v2, s[28:31], s51 offen offset:512
    s_waitcnt vmcnt(63)
    buffer_load_dwordx2 a[180:181], v2, s[28:31], s51 offen offset:1024
    s_waitcnt vmcnt(63)
    buffer_load_dwordx2 a[182:183], v2, s[28:31], s51 offen offset:1536
    s_waitcnt vmcnt(63)
    buffer_load_dwordx2 a[184:185], v2, s[28:31], s51 offen offset:2048
    s_waitcnt vmcnt(63)
    buffer_load_dwordx2 a[186:187], v2, s[28:31], s51 offen offset:2560
    s_waitcnt vmcnt(63)
    buffer_load_dwordx2 a[188:189], v2, s[28:31], s51 offen offset:3072
    s_waitcnt vmcnt(63)
    buffer_load_dwordx2 a[190:191], v2, s[28:31], s51 offen offset:3584
    s_waitcnt vmcnt(63)
    buffer_load_dwordx4 a[192:195], v1, s[28:31], s44 offen offset:0
    s_waitcnt vmcnt(63)
    buffer_load_dwordx4 a[196:199], v1, s[28:31], s45 offen offset:0
    s_waitcnt vmcnt(63)
    buffer_load_dwordx4 a[200:203], v1, s[28:31], s46 offen offset:0
    s_waitcnt vmcnt(63)
    buffer_load_dwordx4 a[204:207], v1, s[28:31], s47 offen offset:0
    s_waitcnt vmcnt(63)
    buffer_load_dwordx4 a[208:211], v1, s[28:31], s44 offen offset:1024
    s_waitcnt vmcnt(63)
    buffer_load_dwordx4 a[212:215], v1, s[28:31], s45 offen offset:1024
    s_waitcnt vmcnt(63)
    buffer_load_dwordx4 a[216:219], v1, s[28:31], s46 offen offset:1024
    s_waitcnt vmcnt(63)
    buffer_load_dwordx4 a[220:223], v1, s[28:31], s47 offen offset:1024
    s_waitcnt vmcnt(63)
    buffer_load_dwordx4 a[224:227], v1, s[28:31], s44 offen offset:2048
    s_waitcnt vmcnt(63)
    buffer_load_dwordx4 a[228:231], v1, s[28:31], s45 offen offset:2048
    s_waitcnt vmcnt(63)
    buffer_load_dwordx4 a[232:235], v1, s[28:31], s46 offen offset:2048
    s_waitcnt vmcnt(63)
    buffer_load_dwordx4 a[236:239], v1, s[28:31], s47 offen offset:2048
    s_waitcnt vmcnt(63)
    buffer_load_dwordx4 a[240:243], v1, s[28:31], s44 offen offset:3072
    s_waitcnt vmcnt(63)
    buffer_load_dwordx4 a[244:247], v1, s[28:31], s45 offen offset:3072
    s_waitcnt vmcnt(63)
    buffer_load_dwordx4 a[248:251], v1, s[28:31], s46 offen offset:3072
    s_waitcnt vmcnt(63)
    buffer_load_dwordx4 a[252:255], v1, s[28:31], s47 offen offset:3072
    s_waitcnt vmcnt(63)
    s_add_u32 s55, s36, 0
    buffer_load_dwordx4 v[16:19], v1, s[28:31], s55 offen
    s_waitcnt vmcnt(63)
    s_add_u32 s55, s37, 0
    buffer_load_dwordx4 v[20:23], v1, s[28:31], s55 offen
    s_waitcnt vmcnt(63)
    s_add_u32 s55, s38, 0
    buffer_load_dwordx4 v[24:27], v1, s[28:31], s55 offen
    s_waitcnt vmcnt(63)
    s_add_u32 s55, s39, 0
    buffer_load_dwordx4 v[28:31], v1, s[28:31], s55 offen
    s_waitcnt vmcnt(63)
    s_add_u32 s56, s40, 0
    buffer_load_dwordx4 v[32:35], v1, s[28:31], s56 offen
    s_waitcnt vmcnt(63)
    s_add_u32 s56, s41, 0
    buffer_load_dwordx4 v[36:39], v1, s[28:31], s56 offen
    s_waitcnt vmcnt(63)
    s_add_u32 s56, s42, 0
    buffer_load_dwordx4 v[40:43], v1, s[28:31], s56 offen
    s_waitcnt vmcnt(63)
    s_add_u32 s56, s43, 0
    buffer_load_dwordx4 v[44:47], v1, s[28:31], s56 offen
    s_waitcnt vmcnt(63)
    s_add_u32 s55, s36, 1024
    buffer_load_dwordx4 v[48:51], v1, s[28:31], s55 offen
    s_waitcnt vmcnt(63)
    s_add_u32 s55, s37, 1024
    buffer_load_dwordx4 v[52:55], v1, s[28:31], s55 offen
    s_waitcnt vmcnt(63)
    s_add_u32 s55, s38, 1024
    buffer_load_dwordx4 v[56:59], v1, s[28:31], s55 offen
    s_waitcnt vmcnt(63)
    s_add_u32 s55, s39, 1024
    buffer_load_dwordx4 v[60:63], v1, s[28:31], s55 offen
    s_waitcnt vmcnt(63)
    s_add_u32 s56, s40, 1024
    buffer_load_dwordx4 v[64:67], v1, s[28:31], s56 offen
    s_waitcnt vmcnt(63)
    s_add_u32 s56, s41, 1024
    buffer_load_dwordx4 v[68:71], v1, s[28:31], s56 offen
    s_waitcnt vmcnt(63)
    s_add_u32 s56, s42, 1024
    buffer_load_dwordx4 v[72:75], v1, s[28:31], s56 offen
    s_waitcnt vmcnt(63)
    s_add_u32 s56, s43, 1024
    buffer_load_dwordx4 v[76:79], v1, s[28:31], s56 offen
    s_waitcnt vmcnt(63)
    s_add_u32 s55, s36, 2048
    buffer_load_dwordx4 v[80:83], v1, s[28:31], s55 offen
    s_waitcnt vmcnt(63)
    s_add_u32 s55, s37, 2048
    buffer_load_dwordx4 v[84:87], v1, s[28:31], s55 offen
    s_waitcnt vmcnt(63)
    s_add_u32 s55, s38, 2048
    buffer_load_dwordx4 v[88:91], v1, s[28:31], s55 offen
    s_waitcnt vmcnt(63)
    s_add_u32 s55, s39, 2048
    buffer_load_dwordx4 v[92:95], v1, s[28:31], s55 offen
    s_waitcnt vmcnt(63)
    s_add_u32 s56, s40, 2048
    buffer_load_dwordx4 v[96:99], v1, s[28:31], s56 offen
    s_waitcnt vmcnt(63)
    s_add_u32 s56, s41, 2048
    buffer_load_dwordx4 v[100:103], v1, s[28:31], s56 offen
    s_waitcnt vmcnt(63)
    s_add_u32 s56, s42, 2048
    buffer_load_dwordx4 v[104:107], v1, s[28:31], s56 offen
    s_waitcnt vmcnt(63)
    s_add_u32 s56, s43, 2048
    buffer_load_dwordx4 v[108:111], v1, s[28:31], s56 offen
    s_waitcnt vmcnt(63)
    v_cvt_pk_bf16_f32 v144, v180, v181
    v_cvt_pk_bf16_f32 v145, v182, v183
    v_cvt_pk_bf16_f32 v146, v184, v185
    v_cvt_pk_bf16_f32 v147, v186, v187
    v_cvt_pk_bf16_f32 v148, v188, v189
    v_cvt_pk_bf16_f32 v149, v190, v191
    v_cvt_pk_bf16_f32 v150, v192, v193
    v_cvt_pk_bf16_f32 v151, v194, v195
    v_cvt_pk_bf16_f32 v152, v196, v197
    v_cvt_pk_bf16_f32 v153, v198, v199
    v_cvt_pk_bf16_f32 v154, v200, v201
    v_cvt_pk_bf16_f32 v155, v202, v203
    v_cvt_pk_bf16_f32 v156, v204, v205
    v_cvt_pk_bf16_f32 v157, v206, v207
    v_cvt_pk_bf16_f32 v158, v208, v209
    v_cvt_pk_bf16_f32 v159, v210, v211
    v_cvt_pk_bf16_f32 v160, v212, v213
    v_cvt_pk_bf16_f32 v161, v214, v215
    v_cvt_pk_bf16_f32 v162, v216, v217
    v_cvt_pk_bf16_f32 v163, v218, v219
    v_cvt_pk_bf16_f32 v164, v220, v221
    v_cvt_pk_bf16_f32 v165, v222, v223
    v_cvt_pk_bf16_f32 v166, v224, v225
    v_cvt_pk_bf16_f32 v167, v226, v227
    v_cvt_pk_bf16_f32 v168, v228, v229
    v_cvt_pk_bf16_f32 v169, v230, v231
    v_cvt_pk_bf16_f32 v170, v232, v233
    v_cvt_pk_bf16_f32 v171, v234, v235
    v_cvt_pk_bf16_f32 v172, v236, v237
    v_cvt_pk_bf16_f32 v173, v238, v239
    v_cvt_pk_bf16_f32 v174, v240, v241
    v_cvt_pk_bf16_f32 v175, v242, v243
    v_mfma_f32_16x16x16_bf16 v[180:183], v[144:145], a[128:129], 0
    v_mfma_f32_16x16x16_bf16 v[188:191], v[146:147], a[128:129], 0
    v_mfma_f32_16x16x16_bf16 v[184:187], v[148:149], a[130:131], 0
    v_mfma_f32_16x16x16_bf16 v[192:195], v[150:151], a[130:131], 0
    s_nop 5
    v_cvt_pk_bf16_f32 v196, v188, v188
    v_lshlrev_b32 v196, 16, v196
    v_add_f32 v196, 0x358637bd, v196
    v_cvt_pk_bf16_f32 v196, v196, v196
    v_lshlrev_b32 v196, 16, v196
    v_rcp_f32 v196, v196
    v_cvt_pk_bf16_f32 v197, v180, v181
    v_cvt_pk_bf16_f32 v198, v182, v183
    v_lshlrev_b32 v180, 16, v197
    v_and_b32 v181, 0xffff0000, v197
    v_lshlrev_b32 v182, 16, v198
    v_and_b32 v183, 0xffff0000, v198
    v_mul_f32 v180, v180, v196
    v_mul_f32 v181, v181, v196
    v_mul_f32 v182, v182, v196
    v_mul_f32 v183, v183, v196
    v_cvt_pk_bf16_f32 v176, v180, v181
    v_cvt_pk_bf16_f32 v177, v182, v183
    v_cvt_pk_bf16_f32 v204, v192, v192
    v_lshlrev_b32 v204, 16, v204
    v_add_f32 v204, 0x358637bd, v204
    v_cvt_pk_bf16_f32 v204, v204, v204
    v_lshlrev_b32 v204, 16, v204
    v_rcp_f32 v204, v204
    v_cvt_pk_bf16_f32 v205, v184, v185
    v_cvt_pk_bf16_f32 v206, v186, v187
    v_lshlrev_b32 v184, 16, v205
    v_and_b32 v185, 0xffff0000, v205
    v_lshlrev_b32 v186, 16, v206
    v_and_b32 v187, 0xffff0000, v206
    v_mul_f32 v184, v184, v204
    v_mul_f32 v185, v185, v204
    v_mul_f32 v186, v186, v204
    v_mul_f32 v187, v187, v204
    v_cvt_pk_bf16_f32 v178, v184, v185
    v_cvt_pk_bf16_f32 v179, v186, v187
    s_waitcnt vmcnt(39)
    s_nop 1
    v_mfma_f32_16x16x32_bf16 a[64:67], a[192:195], v[176:179], 0
    s_waitcnt vmcnt(38)
    v_mfma_f32_16x16x32_bf16 a[68:71], a[196:199], v[176:179], 0
    s_waitcnt vmcnt(37)
    v_mfma_f32_16x16x32_bf16 a[72:75], a[200:203], v[176:179], 0
    s_waitcnt vmcnt(36)
    v_mfma_f32_16x16x32_bf16 a[76:79], a[204:207], v[176:179], 0
    v_mfma_f32_16x16x16_bf16 v[180:183], v[144:145], a[144:145], 0
    v_mfma_f32_16x16x16_bf16 v[188:191], v[146:147], a[144:145], 0
    v_mfma_f32_16x16x16_bf16 v[184:187], v[148:149], a[146:147], 0
    v_mfma_f32_16x16x16_bf16 v[192:195], v[150:151], a[146:147], 0
    s_nop 5
    v_cvt_pk_bf16_f32 v196, v188, v188
    v_lshlrev_b32 v196, 16, v196
    v_add_f32 v196, 0x358637bd, v196
    v_cvt_pk_bf16_f32 v196, v196, v196
    v_lshlrev_b32 v196, 16, v196
    v_rcp_f32 v196, v196
    v_cvt_pk_bf16_f32 v197, v180, v181
    v_cvt_pk_bf16_f32 v198, v182, v183
    v_lshlrev_b32 v180, 16, v197
    v_and_b32 v181, 0xffff0000, v197
    v_lshlrev_b32 v182, 16, v198
    v_and_b32 v183, 0xffff0000, v198
    v_mul_f32 v180, v180, v196
    v_mul_f32 v181, v181, v196
    v_mul_f32 v182, v182, v196
    v_mul_f32 v183, v183, v196
    v_cvt_pk_bf16_f32 v176, v180, v181
    v_cvt_pk_bf16_f32 v177, v182, v183
    v_cvt_pk_bf16_f32 v204, v192, v192
    v_lshlrev_b32 v204, 16, v204
    v_add_f32 v204, 0x358637bd, v204
    v_cvt_pk_bf16_f32 v204, v204, v204
    v_lshlrev_b32 v204, 16, v204
    v_rcp_f32 v204, v204
    v_cvt_pk_bf16_f32 v205, v184, v185
    v_cvt_pk_bf16_f32 v206, v186, v187
    v_lshlrev_b32 v184, 16, v205
    v_and_b32 v185, 0xffff0000, v205
    v_lshlrev_b32 v186, 16, v206
    v_and_b32 v187, 0xffff0000, v206
    v_mul_f32 v184, v184, v204
    v_mul_f32 v185, v185, v204
    v_mul_f32 v186, v186, v204
    v_mul_f32 v187, v187, v204
    v_cvt_pk_bf16_f32 v178, v184, v185
    v_cvt_pk_bf16_f32 v179, v186, v187
    s_nop 1
    v_mfma_f32_16x16x32_bf16 a[80:83], a[192:195], v[176:179], 0
    v_mfma_f32_16x16x32_bf16 a[84:87], a[196:199], v[176:179], 0
    v_mfma_f32_16x16x32_bf16 a[88:91], a[200:203], v[176:179], 0
    v_mfma_f32_16x16x32_bf16 a[92:95], a[204:207], v[176:179], 0
    v_mfma_f32_16x16x16_bf16 v[180:183], v[144:145], a[160:161], 0
    v_mfma_f32_16x16x16_bf16 v[188:191], v[146:147], a[160:161], 0
    v_mfma_f32_16x16x16_bf16 v[184:187], v[148:149], a[162:163], 0
    v_mfma_f32_16x16x16_bf16 v[192:195], v[150:151], a[162:163], 0
    s_nop 5
    v_cvt_pk_bf16_f32 v196, v188, v188
    v_lshlrev_b32 v196, 16, v196
    v_add_f32 v196, 0x358637bd, v196
    v_cvt_pk_bf16_f32 v196, v196, v196
    v_lshlrev_b32 v196, 16, v196
    v_rcp_f32 v196, v196
    v_cvt_pk_bf16_f32 v197, v180, v181
    v_cvt_pk_bf16_f32 v198, v182, v183
    v_lshlrev_b32 v180, 16, v197
    v_and_b32 v181, 0xffff0000, v197
    v_lshlrev_b32 v182, 16, v198
    v_and_b32 v183, 0xffff0000, v198
    v_mul_f32 v180, v180, v196
    v_mul_f32 v181, v181, v196
    v_mul_f32 v182, v182, v196
    v_mul_f32 v183, v183, v196
    v_cvt_pk_bf16_f32 v176, v180, v181
    v_cvt_pk_bf16_f32 v177, v182, v183
    v_cvt_pk_bf16_f32 v204, v192, v192
    v_lshlrev_b32 v204, 16, v204
    v_add_f32 v204, 0x358637bd, v204
    v_cvt_pk_bf16_f32 v204, v204, v204
    v_lshlrev_b32 v204, 16, v204
    v_rcp_f32 v204, v204
    v_cvt_pk_bf16_f32 v205, v184, v185
    v_cvt_pk_bf16_f32 v206, v186, v187
    v_lshlrev_b32 v184, 16, v205
    v_and_b32 v185, 0xffff0000, v205
    v_lshlrev_b32 v186, 16, v206
    v_and_b32 v187, 0xffff0000, v206
    v_mul_f32 v184, v184, v204
    v_mul_f32 v185, v185, v204
    v_mul_f32 v186, v186, v204
    v_mul_f32 v187, v187, v204
    v_cvt_pk_bf16_f32 v178, v184, v185
    v_cvt_pk_bf16_f32 v179, v186, v187
    s_nop 1
    v_mfma_f32_16x16x32_bf16 a[96:99], a[192:195], v[176:179], 0
    v_mfma_f32_16x16x32_bf16 a[100:103], a[196:199], v[176:179], 0
    v_mfma_f32_16x16x32_bf16 a[104:107], a[200:203], v[176:179], 0
    v_mfma_f32_16x16x32_bf16 a[108:111], a[204:207], v[176:179], 0
    s_add_u32 s55, s36, 3072
    buffer_load_dwordx4 v[112:115], v1, s[28:31], s55 offen
    s_add_u32 s55, s37, 3072
    buffer_load_dwordx4 v[116:119], v1, s[28:31], s55 offen
    s_add_u32 s55, s38, 3072
    buffer_load_dwordx4 v[120:123], v1, s[28:31], s55 offen
    s_add_u32 s55, s39, 3072
    buffer_load_dwordx4 v[124:127], v1, s[28:31], s55 offen
    s_add_u32 s56, s40, 3072
    buffer_load_dwordx4 v[128:131], v1, s[28:31], s56 offen
    s_add_u32 s56, s41, 3072
    buffer_load_dwordx4 v[132:135], v1, s[28:31], s56 offen
    s_add_u32 s56, s42, 3072
    buffer_load_dwordx4 v[136:139], v1, s[28:31], s56 offen
    s_add_u32 s56, s43, 3072
    buffer_load_dwordx4 v[140:143], v1, s[28:31], s56 offen
    s_waitcnt vmcnt(27)
    v_mfma_f32_16x16x32_bf16 a[0:3], v[16:19], v[32:35], 0
    v_mfma_f32_16x16x32_bf16 a[4:7], v[20:23], v[32:35], 0
    v_mfma_f32_16x16x32_bf16 a[8:11], v[24:27], v[32:35], 0
    v_mfma_f32_16x16x32_bf16 a[12:15], v[28:31], v[32:35], 0
    s_waitcnt vmcnt(26)
    v_mfma_f32_16x16x32_bf16 a[16:19], v[16:19], v[36:39], 0
    v_mfma_f32_16x16x32_bf16 a[20:23], v[20:23], v[36:39], 0
    v_mfma_f32_16x16x32_bf16 a[24:27], v[24:27], v[36:39], 0
    v_mfma_f32_16x16x32_bf16 a[28:31], v[28:31], v[36:39], 0
    s_waitcnt vmcnt(25)
    v_mfma_f32_16x16x32_bf16 a[32:35], v[16:19], v[40:43], 0
    v_mfma_f32_16x16x32_bf16 a[36:39], v[20:23], v[40:43], 0
    v_mfma_f32_16x16x32_bf16 a[40:43], v[24:27], v[40:43], 0
    v_mfma_f32_16x16x32_bf16 a[44:47], v[28:31], v[40:43], 0
    s_waitcnt vmcnt(24)
    v_mfma_f32_16x16x32_bf16 a[48:51], v[16:19], v[44:47], 0
    v_mfma_f32_16x16x32_bf16 a[52:55], v[20:23], v[44:47], 0
    v_mfma_f32_16x16x32_bf16 a[56:59], v[24:27], v[44:47], 0
    v_mfma_f32_16x16x32_bf16 a[60:63], v[28:31], v[44:47], 0
    v_mfma_f32_16x16x16_bf16 v[180:183], v[144:145], a[176:177], 0
    v_mfma_f32_16x16x16_bf16 v[188:191], v[146:147], a[176:177], 0
    v_mfma_f32_16x16x16_bf16 v[184:187], v[148:149], a[178:179], 0
    v_mfma_f32_16x16x16_bf16 v[192:195], v[150:151], a[178:179], 0
    s_nop 5
    v_cvt_pk_bf16_f32 v196, v188, v188
    v_lshlrev_b32 v196, 16, v196
    v_add_f32 v196, 0x358637bd, v196
    v_cvt_pk_bf16_f32 v196, v196, v196
    v_lshlrev_b32 v196, 16, v196
    v_rcp_f32 v196, v196
    v_cvt_pk_bf16_f32 v197, v180, v181
    v_cvt_pk_bf16_f32 v198, v182, v183
    v_lshlrev_b32 v180, 16, v197
    v_and_b32 v181, 0xffff0000, v197
    v_lshlrev_b32 v182, 16, v198
    v_and_b32 v183, 0xffff0000, v198
    v_mul_f32 v180, v180, v196
    v_mul_f32 v181, v181, v196
    v_mul_f32 v182, v182, v196
    v_mul_f32 v183, v183, v196
    v_cvt_pk_bf16_f32 v176, v180, v181
    v_cvt_pk_bf16_f32 v177, v182, v183
    v_cvt_pk_bf16_f32 v204, v192, v192
    v_lshlrev_b32 v204, 16, v204
    v_add_f32 v204, 0x358637bd, v204
    v_cvt_pk_bf16_f32 v204, v204, v204
    v_lshlrev_b32 v204, 16, v204
    v_rcp_f32 v204, v204
    v_cvt_pk_bf16_f32 v205, v184, v185
    v_cvt_pk_bf16_f32 v206, v186, v187
    v_lshlrev_b32 v184, 16, v205
    v_and_b32 v185, 0xffff0000, v205
    v_lshlrev_b32 v186, 16, v206
    v_and_b32 v187, 0xffff0000, v206
    v_mul_f32 v184, v184, v204
    v_mul_f32 v185, v185, v204
    v_mul_f32 v186, v186, v204
    v_mul_f32 v187, v187, v204
    v_cvt_pk_bf16_f32 v178, v184, v185
    v_cvt_pk_bf16_f32 v179, v186, v187
    s_nop 1
    v_mfma_f32_16x16x32_bf16 a[112:115], a[192:195], v[176:179], 0
    v_mfma_f32_16x16x32_bf16 a[116:119], a[196:199], v[176:179], 0
    v_mfma_f32_16x16x32_bf16 a[120:123], a[200:203], v[176:179], 0
    v_mfma_f32_16x16x32_bf16 a[124:127], a[204:207], v[176:179], 0
    s_add_u32 s55, s36, 4096
    buffer_load_dwordx4 v[16:19], v1, s[28:31], s55 offen
    s_add_u32 s55, s37, 4096
    buffer_load_dwordx4 v[20:23], v1, s[28:31], s55 offen
    s_add_u32 s55, s38, 4096
    buffer_load_dwordx4 v[24:27], v1, s[28:31], s55 offen
    s_add_u32 s55, s39, 4096
    buffer_load_dwordx4 v[28:31], v1, s[28:31], s55 offen
    s_add_u32 s56, s40, 4096
    buffer_load_dwordx4 v[32:35], v1, s[28:31], s56 offen
    s_add_u32 s56, s41, 4096
    buffer_load_dwordx4 v[36:39], v1, s[28:31], s56 offen
    s_add_u32 s56, s42, 4096
    buffer_load_dwordx4 v[40:43], v1, s[28:31], s56 offen
    s_add_u32 s56, s43, 4096
    buffer_load_dwordx4 v[44:47], v1, s[28:31], s56 offen
    s_waitcnt vmcnt(27)
    v_mfma_f32_16x16x32_bf16 a[0:3], v[48:51], v[64:67], a[0:3]
    v_mfma_f32_16x16x32_bf16 a[4:7], v[52:55], v[64:67], a[4:7]
    v_mfma_f32_16x16x32_bf16 a[8:11], v[56:59], v[64:67], a[8:11]
    v_mfma_f32_16x16x32_bf16 a[12:15], v[60:63], v[64:67], a[12:15]
    s_waitcnt vmcnt(26)
    v_mfma_f32_16x16x32_bf16 a[16:19], v[48:51], v[68:71], a[16:19]
    v_mfma_f32_16x16x32_bf16 a[20:23], v[52:55], v[68:71], a[20:23]
    v_mfma_f32_16x16x32_bf16 a[24:27], v[56:59], v[68:71], a[24:27]
    v_mfma_f32_16x16x32_bf16 a[28:31], v[60:63], v[68:71], a[28:31]
    s_waitcnt vmcnt(25)
    v_mfma_f32_16x16x32_bf16 a[32:35], v[48:51], v[72:75], a[32:35]
    v_mfma_f32_16x16x32_bf16 a[36:39], v[52:55], v[72:75], a[36:39]
    v_mfma_f32_16x16x32_bf16 a[40:43], v[56:59], v[72:75], a[40:43]
    v_mfma_f32_16x16x32_bf16 a[44:47], v[60:63], v[72:75], a[44:47]
    s_waitcnt vmcnt(24)
    v_mfma_f32_16x16x32_bf16 a[48:51], v[48:51], v[76:79], a[48:51]
    v_mfma_f32_16x16x32_bf16 a[52:55], v[52:55], v[76:79], a[52:55]
    v_mfma_f32_16x16x32_bf16 a[56:59], v[56:59], v[76:79], a[56:59]
    v_mfma_f32_16x16x32_bf16 a[60:63], v[60:63], v[76:79], a[60:63]
    v_mfma_f32_16x16x16_bf16 v[180:183], v[152:153], a[132:133], 0
    v_mfma_f32_16x16x16_bf16 v[188:191], v[154:155], a[132:133], 0
    v_mfma_f32_16x16x16_bf16 v[184:187], v[156:157], a[134:135], 0
    v_mfma_f32_16x16x16_bf16 v[192:195], v[158:159], a[134:135], 0
    s_nop 5
    v_cvt_pk_bf16_f32 v196, v188, v188
    v_lshlrev_b32 v196, 16, v196
    v_add_f32 v196, 0x358637bd, v196
    v_cvt_pk_bf16_f32 v196, v196, v196
    v_lshlrev_b32 v196, 16, v196
    v_rcp_f32 v196, v196
    v_cvt_pk_bf16_f32 v197, v180, v181
    v_cvt_pk_bf16_f32 v198, v182, v183
    v_lshlrev_b32 v180, 16, v197
    v_and_b32 v181, 0xffff0000, v197
    v_lshlrev_b32 v182, 16, v198
    v_and_b32 v183, 0xffff0000, v198
    v_mul_f32 v180, v180, v196
    v_mul_f32 v181, v181, v196
    v_mul_f32 v182, v182, v196
    v_mul_f32 v183, v183, v196
    v_cvt_pk_bf16_f32 v176, v180, v181
    v_cvt_pk_bf16_f32 v177, v182, v183
    v_cvt_pk_bf16_f32 v204, v192, v192
    v_lshlrev_b32 v204, 16, v204
    v_add_f32 v204, 0x358637bd, v204
    v_cvt_pk_bf16_f32 v204, v204, v204
    v_lshlrev_b32 v204, 16, v204
    v_rcp_f32 v204, v204
    v_cvt_pk_bf16_f32 v205, v184, v185
    v_cvt_pk_bf16_f32 v206, v186, v187
    v_lshlrev_b32 v184, 16, v205
    v_and_b32 v185, 0xffff0000, v205
    v_lshlrev_b32 v186, 16, v206
    v_and_b32 v187, 0xffff0000, v206
    v_mul_f32 v184, v184, v204
    v_mul_f32 v185, v185, v204
    v_mul_f32 v186, v186, v204
    v_mul_f32 v187, v187, v204
    v_cvt_pk_bf16_f32 v178, v184, v185
    v_cvt_pk_bf16_f32 v179, v186, v187
    s_nop 1
    v_mfma_f32_16x16x32_bf16 a[64:67], a[208:211], v[176:179], a[64:67]
    v_mfma_f32_16x16x32_bf16 a[68:71], a[212:215], v[176:179], a[68:71]
    v_mfma_f32_16x16x32_bf16 a[72:75], a[216:219], v[176:179], a[72:75]
    v_mfma_f32_16x16x32_bf16 a[76:79], a[220:223], v[176:179], a[76:79]
    s_add_u32 s55, s36, 5120
    buffer_load_dwordx4 v[48:51], v1, s[28:31], s55 offen
    s_add_u32 s55, s37, 5120
    buffer_load_dwordx4 v[52:55], v1, s[28:31], s55 offen
    s_add_u32 s55, s38, 5120
    buffer_load_dwordx4 v[56:59], v1, s[28:31], s55 offen
    s_add_u32 s55, s39, 5120
    buffer_load_dwordx4 v[60:63], v1, s[28:31], s55 offen
    s_add_u32 s56, s40, 5120
    buffer_load_dwordx4 v[64:67], v1, s[28:31], s56 offen
    s_add_u32 s56, s41, 5120
    buffer_load_dwordx4 v[68:71], v1, s[28:31], s56 offen
    s_add_u32 s56, s42, 5120
    buffer_load_dwordx4 v[72:75], v1, s[28:31], s56 offen
    s_add_u32 s56, s43, 5120
    buffer_load_dwordx4 v[76:79], v1, s[28:31], s56 offen
    s_waitcnt vmcnt(27)
    v_mfma_f32_16x16x32_bf16 a[0:3], v[80:83], v[96:99], a[0:3]
    v_mfma_f32_16x16x32_bf16 a[4:7], v[84:87], v[96:99], a[4:7]
    v_mfma_f32_16x16x32_bf16 a[8:11], v[88:91], v[96:99], a[8:11]
    v_mfma_f32_16x16x32_bf16 a[12:15], v[92:95], v[96:99], a[12:15]
    s_waitcnt vmcnt(26)
    v_mfma_f32_16x16x32_bf16 a[16:19], v[80:83], v[100:103], a[16:19]
    v_mfma_f32_16x16x32_bf16 a[20:23], v[84:87], v[100:103], a[20:23]
    v_mfma_f32_16x16x32_bf16 a[24:27], v[88:91], v[100:103], a[24:27]
    v_mfma_f32_16x16x32_bf16 a[28:31], v[92:95], v[100:103], a[28:31]
    s_waitcnt vmcnt(25)
    v_mfma_f32_16x16x32_bf16 a[32:35], v[80:83], v[104:107], a[32:35]
    v_mfma_f32_16x16x32_bf16 a[36:39], v[84:87], v[104:107], a[36:39]
    v_mfma_f32_16x16x32_bf16 a[40:43], v[88:91], v[104:107], a[40:43]
    v_mfma_f32_16x16x32_bf16 a[44:47], v[92:95], v[104:107], a[44:47]
    s_waitcnt vmcnt(24)
    v_mfma_f32_16x16x32_bf16 a[48:51], v[80:83], v[108:111], a[48:51]
    v_mfma_f32_16x16x32_bf16 a[52:55], v[84:87], v[108:111], a[52:55]
    v_mfma_f32_16x16x32_bf16 a[56:59], v[88:91], v[108:111], a[56:59]
    v_mfma_f32_16x16x32_bf16 a[60:63], v[92:95], v[108:111], a[60:63]
    v_mfma_f32_16x16x16_bf16 v[180:183], v[152:153], a[148:149], 0
    v_mfma_f32_16x16x16_bf16 v[188:191], v[154:155], a[148:149], 0
    v_mfma_f32_16x16x16_bf16 v[184:187], v[156:157], a[150:151], 0
    v_mfma_f32_16x16x16_bf16 v[192:195], v[158:159], a[150:151], 0
    s_nop 5
    v_cvt_pk_bf16_f32 v196, v188, v188
    v_lshlrev_b32 v196, 16, v196
    v_add_f32 v196, 0x358637bd, v196
    v_cvt_pk_bf16_f32 v196, v196, v196
    v_lshlrev_b32 v196, 16, v196
    v_rcp_f32 v196, v196
    v_cvt_pk_bf16_f32 v197, v180, v181
    v_cvt_pk_bf16_f32 v198, v182, v183
    v_lshlrev_b32 v180, 16, v197
    v_and_b32 v181, 0xffff0000, v197
    v_lshlrev_b32 v182, 16, v198
    v_and_b32 v183, 0xffff0000, v198
    v_mul_f32 v180, v180, v196
    v_mul_f32 v181, v181, v196
    v_mul_f32 v182, v182, v196
    v_mul_f32 v183, v183, v196
    v_cvt_pk_bf16_f32 v176, v180, v181
    v_cvt_pk_bf16_f32 v177, v182, v183
    v_cvt_pk_bf16_f32 v204, v192, v192
    v_lshlrev_b32 v204, 16, v204
    v_add_f32 v204, 0x358637bd, v204
    v_cvt_pk_bf16_f32 v204, v204, v204
    v_lshlrev_b32 v204, 16, v204
    v_rcp_f32 v204, v204
    v_cvt_pk_bf16_f32 v205, v184, v185
    v_cvt_pk_bf16_f32 v206, v186, v187
    v_lshlrev_b32 v184, 16, v205
    v_and_b32 v185, 0xffff0000, v205
    v_lshlrev_b32 v186, 16, v206
    v_and_b32 v187, 0xffff0000, v206
    v_mul_f32 v184, v184, v204
    v_mul_f32 v185, v185, v204
    v_mul_f32 v186, v186, v204
    v_mul_f32 v187, v187, v204
    v_cvt_pk_bf16_f32 v178, v184, v185
    v_cvt_pk_bf16_f32 v179, v186, v187
    s_nop 1
    v_mfma_f32_16x16x32_bf16 a[80:83], a[208:211], v[176:179], a[80:83]
    v_mfma_f32_16x16x32_bf16 a[84:87], a[212:215], v[176:179], a[84:87]
    v_mfma_f32_16x16x32_bf16 a[88:91], a[216:219], v[176:179], a[88:91]
    v_mfma_f32_16x16x32_bf16 a[92:95], a[220:223], v[176:179], a[92:95]
    s_add_u32 s55, s36, 6144
    buffer_load_dwordx4 v[80:83], v1, s[28:31], s55 offen
    s_add_u32 s55, s37, 6144
    buffer_load_dwordx4 v[84:87], v1, s[28:31], s55 offen
    s_add_u32 s55, s38, 6144
    buffer_load_dwordx4 v[88:91], v1, s[28:31], s55 offen
    s_add_u32 s55, s39, 6144
    buffer_load_dwordx4 v[92:95], v1, s[28:31], s55 offen
    s_add_u32 s56, s40, 6144
    buffer_load_dwordx4 v[96:99], v1, s[28:31], s56 offen
    s_add_u32 s56, s41, 6144
    buffer_load_dwordx4 v[100:103], v1, s[28:31], s56 offen
    s_add_u32 s56, s42, 6144
    buffer_load_dwordx4 v[104:107], v1, s[28:31], s56 offen
    s_add_u32 s56, s43, 6144
    buffer_load_dwordx4 v[108:111], v1, s[28:31], s56 offen
    s_waitcnt vmcnt(27)
    v_mfma_f32_16x16x32_bf16 a[0:3], v[112:115], v[128:131], a[0:3]
    v_mfma_f32_16x16x32_bf16 a[4:7], v[116:119], v[128:131], a[4:7]
    v_mfma_f32_16x16x32_bf16 a[8:11], v[120:123], v[128:131], a[8:11]
    v_mfma_f32_16x16x32_bf16 a[12:15], v[124:127], v[128:131], a[12:15]
    s_waitcnt vmcnt(26)
    v_mfma_f32_16x16x32_bf16 a[16:19], v[112:115], v[132:135], a[16:19]
    v_mfma_f32_16x16x32_bf16 a[20:23], v[116:119], v[132:135], a[20:23]
    v_mfma_f32_16x16x32_bf16 a[24:27], v[120:123], v[132:135], a[24:27]
    v_mfma_f32_16x16x32_bf16 a[28:31], v[124:127], v[132:135], a[28:31]
    s_waitcnt vmcnt(25)
    v_mfma_f32_16x16x32_bf16 a[32:35], v[112:115], v[136:139], a[32:35]
    v_mfma_f32_16x16x32_bf16 a[36:39], v[116:119], v[136:139], a[36:39]
    v_mfma_f32_16x16x32_bf16 a[40:43], v[120:123], v[136:139], a[40:43]
    v_mfma_f32_16x16x32_bf16 a[44:47], v[124:127], v[136:139], a[44:47]
    s_waitcnt vmcnt(24)
    v_mfma_f32_16x16x32_bf16 a[48:51], v[112:115], v[140:143], a[48:51]
    v_mfma_f32_16x16x32_bf16 a[52:55], v[116:119], v[140:143], a[52:55]
    v_mfma_f32_16x16x32_bf16 a[56:59], v[120:123], v[140:143], a[56:59]
    v_mfma_f32_16x16x32_bf16 a[60:63], v[124:127], v[140:143], a[60:63]
    v_mfma_f32_16x16x16_bf16 v[180:183], v[152:153], a[164:165], 0
    v_mfma_f32_16x16x16_bf16 v[188:191], v[154:155], a[164:165], 0
    v_mfma_f32_16x16x16_bf16 v[184:187], v[156:157], a[166:167], 0
    v_mfma_f32_16x16x16_bf16 v[192:195], v[158:159], a[166:167], 0
    s_nop 5
    v_cvt_pk_bf16_f32 v196, v188, v188
    v_lshlrev_b32 v196, 16, v196
    v_add_f32 v196, 0x358637bd, v196
    v_cvt_pk_bf16_f32 v196, v196, v196
    v_lshlrev_b32 v196, 16, v196
    v_rcp_f32 v196, v196
    v_cvt_pk_bf16_f32 v197, v180, v181
    v_cvt_pk_bf16_f32 v198, v182, v183
    v_lshlrev_b32 v180, 16, v197
    v_and_b32 v181, 0xffff0000, v197
    v_lshlrev_b32 v182, 16, v198
    v_and_b32 v183, 0xffff0000, v198
    v_mul_f32 v180, v180, v196
    v_mul_f32 v181, v181, v196
    v_mul_f32 v182, v182, v196
    v_mul_f32 v183, v183, v196
    v_cvt_pk_bf16_f32 v176, v180, v181
    v_cvt_pk_bf16_f32 v177, v182, v183
    v_cvt_pk_bf16_f32 v204, v192, v192
    v_lshlrev_b32 v204, 16, v204
    v_add_f32 v204, 0x358637bd, v204
    v_cvt_pk_bf16_f32 v204, v204, v204
    v_lshlrev_b32 v204, 16, v204
    v_rcp_f32 v204, v204
    v_cvt_pk_bf16_f32 v205, v184, v185
    v_cvt_pk_bf16_f32 v206, v186, v187
    v_lshlrev_b32 v184, 16, v205
    v_and_b32 v185, 0xffff0000, v205
    v_lshlrev_b32 v186, 16, v206
    v_and_b32 v187, 0xffff0000, v206
    v_mul_f32 v184, v184, v204
    v_mul_f32 v185, v185, v204
    v_mul_f32 v186, v186, v204
    v_mul_f32 v187, v187, v204
    v_cvt_pk_bf16_f32 v178, v184, v185
    v_cvt_pk_bf16_f32 v179, v186, v187
    s_nop 1
    v_mfma_f32_16x16x32_bf16 a[96:99], a[208:211], v[176:179], a[96:99]
    v_mfma_f32_16x16x32_bf16 a[100:103], a[212:215], v[176:179], a[100:103]
    v_mfma_f32_16x16x32_bf16 a[104:107], a[216:219], v[176:179], a[104:107]
    v_mfma_f32_16x16x32_bf16 a[108:111], a[220:223], v[176:179], a[108:111]
    s_add_u32 s55, s36, 7168
    buffer_load_dwordx4 v[112:115], v1, s[28:31], s55 offen
    s_add_u32 s55, s37, 7168
    buffer_load_dwordx4 v[116:119], v1, s[28:31], s55 offen
    s_add_u32 s55, s38, 7168
    buffer_load_dwordx4 v[120:123], v1, s[28:31], s55 offen
    s_add_u32 s55, s39, 7168
    buffer_load_dwordx4 v[124:127], v1, s[28:31], s55 offen
    s_add_u32 s56, s40, 7168
    buffer_load_dwordx4 v[128:131], v1, s[28:31], s56 offen
    s_add_u32 s56, s41, 7168
    buffer_load_dwordx4 v[132:135], v1, s[28:31], s56 offen
    s_add_u32 s56, s42, 7168
    buffer_load_dwordx4 v[136:139], v1, s[28:31], s56 offen
    s_add_u32 s56, s43, 7168
    buffer_load_dwordx4 v[140:143], v1, s[28:31], s56 offen
    s_waitcnt vmcnt(27)
    v_mfma_f32_16x16x32_bf16 a[0:3], v[16:19], v[32:35], a[0:3]
    v_mfma_f32_16x16x32_bf16 a[4:7], v[20:23], v[32:35], a[4:7]
    v_mfma_f32_16x16x32_bf16 a[8:11], v[24:27], v[32:35], a[8:11]
    v_mfma_f32_16x16x32_bf16 a[12:15], v[28:31], v[32:35], a[12:15]
    s_waitcnt vmcnt(26)
    v_mfma_f32_16x16x32_bf16 a[16:19], v[16:19], v[36:39], a[16:19]
    v_mfma_f32_16x16x32_bf16 a[20:23], v[20:23], v[36:39], a[20:23]
    v_mfma_f32_16x16x32_bf16 a[24:27], v[24:27], v[36:39], a[24:27]
    v_mfma_f32_16x16x32_bf16 a[28:31], v[28:31], v[36:39], a[28:31]
    s_waitcnt vmcnt(25)
    v_mfma_f32_16x16x32_bf16 a[32:35], v[16:19], v[40:43], a[32:35]
    v_mfma_f32_16x16x32_bf16 a[36:39], v[20:23], v[40:43], a[36:39]
    v_mfma_f32_16x16x32_bf16 a[40:43], v[24:27], v[40:43], a[40:43]
    v_mfma_f32_16x16x32_bf16 a[44:47], v[28:31], v[40:43], a[44:47]
    s_waitcnt vmcnt(24)
    v_mfma_f32_16x16x32_bf16 a[48:51], v[16:19], v[44:47], a[48:51]
    v_mfma_f32_16x16x32_bf16 a[52:55], v[20:23], v[44:47], a[52:55]
    v_mfma_f32_16x16x32_bf16 a[56:59], v[24:27], v[44:47], a[56:59]
    v_mfma_f32_16x16x32_bf16 a[60:63], v[28:31], v[44:47], a[60:63]
    v_mfma_f32_16x16x16_bf16 v[180:183], v[152:153], a[180:181], 0
    v_mfma_f32_16x16x16_bf16 v[188:191], v[154:155], a[180:181], 0
    v_mfma_f32_16x16x16_bf16 v[184:187], v[156:157], a[182:183], 0
    v_mfma_f32_16x16x16_bf16 v[192:195], v[158:159], a[182:183], 0
    s_nop 5
    v_cvt_pk_bf16_f32 v196, v188, v188
    v_lshlrev_b32 v196, 16, v196
    v_add_f32 v196, 0x358637bd, v196
    v_cvt_pk_bf16_f32 v196, v196, v196
    v_lshlrev_b32 v196, 16, v196
    v_rcp_f32 v196, v196
    v_cvt_pk_bf16_f32 v197, v180, v181
    v_cvt_pk_bf16_f32 v198, v182, v183
    v_lshlrev_b32 v180, 16, v197
    v_and_b32 v181, 0xffff0000, v197
    v_lshlrev_b32 v182, 16, v198
    v_and_b32 v183, 0xffff0000, v198
    v_mul_f32 v180, v180, v196
    v_mul_f32 v181, v181, v196
    v_mul_f32 v182, v182, v196
    v_mul_f32 v183, v183, v196
    v_cvt_pk_bf16_f32 v176, v180, v181
    v_cvt_pk_bf16_f32 v177, v182, v183
    v_cvt_pk_bf16_f32 v204, v192, v192
    v_lshlrev_b32 v204, 16, v204
    v_add_f32 v204, 0x358637bd, v204
    v_cvt_pk_bf16_f32 v204, v204, v204
    v_lshlrev_b32 v204, 16, v204
    v_rcp_f32 v204, v204
    v_cvt_pk_bf16_f32 v205, v184, v185
    v_cvt_pk_bf16_f32 v206, v186, v187
    v_lshlrev_b32 v184, 16, v205
    v_and_b32 v185, 0xffff0000, v205
    v_lshlrev_b32 v186, 16, v206
    v_and_b32 v187, 0xffff0000, v206
    v_mul_f32 v184, v184, v204
    v_mul_f32 v185, v185, v204
    v_mul_f32 v186, v186, v204
    v_mul_f32 v187, v187, v204
    v_cvt_pk_bf16_f32 v178, v184, v185
    v_cvt_pk_bf16_f32 v179, v186, v187
    s_nop 1
    v_mfma_f32_16x16x32_bf16 a[112:115], a[208:211], v[176:179], a[112:115]
    v_mfma_f32_16x16x32_bf16 a[116:119], a[212:215], v[176:179], a[116:119]
    v_mfma_f32_16x16x32_bf16 a[120:123], a[216:219], v[176:179], a[120:123]
    v_mfma_f32_16x16x32_bf16 a[124:127], a[220:223], v[176:179], a[124:127]
    s_add_u32 s55, s36, 8192
    buffer_load_dwordx4 v[16:19], v1, s[28:31], s55 offen
    s_add_u32 s55, s37, 8192
    buffer_load_dwordx4 v[20:23], v1, s[28:31], s55 offen
    s_add_u32 s55, s38, 8192
    buffer_load_dwordx4 v[24:27], v1, s[28:31], s55 offen
    s_add_u32 s55, s39, 8192
    buffer_load_dwordx4 v[28:31], v1, s[28:31], s55 offen
    s_add_u32 s56, s40, 8192
    buffer_load_dwordx4 v[32:35], v1, s[28:31], s56 offen
    s_add_u32 s56, s41, 8192
    buffer_load_dwordx4 v[36:39], v1, s[28:31], s56 offen
    s_add_u32 s56, s42, 8192
    buffer_load_dwordx4 v[40:43], v1, s[28:31], s56 offen
    s_add_u32 s56, s43, 8192
    buffer_load_dwordx4 v[44:47], v1, s[28:31], s56 offen
    s_waitcnt vmcnt(27)
    v_mfma_f32_16x16x32_bf16 a[0:3], v[48:51], v[64:67], a[0:3]
    v_mfma_f32_16x16x32_bf16 a[4:7], v[52:55], v[64:67], a[4:7]
    v_mfma_f32_16x16x32_bf16 a[8:11], v[56:59], v[64:67], a[8:11]
    v_mfma_f32_16x16x32_bf16 a[12:15], v[60:63], v[64:67], a[12:15]
    s_waitcnt vmcnt(26)
    v_mfma_f32_16x16x32_bf16 a[16:19], v[48:51], v[68:71], a[16:19]
    v_mfma_f32_16x16x32_bf16 a[20:23], v[52:55], v[68:71], a[20:23]
    v_mfma_f32_16x16x32_bf16 a[24:27], v[56:59], v[68:71], a[24:27]
    v_mfma_f32_16x16x32_bf16 a[28:31], v[60:63], v[68:71], a[28:31]
    s_waitcnt vmcnt(25)
    v_mfma_f32_16x16x32_bf16 a[32:35], v[48:51], v[72:75], a[32:35]
    v_mfma_f32_16x16x32_bf16 a[36:39], v[52:55], v[72:75], a[36:39]
    v_mfma_f32_16x16x32_bf16 a[40:43], v[56:59], v[72:75], a[40:43]
    v_mfma_f32_16x16x32_bf16 a[44:47], v[60:63], v[72:75], a[44:47]
    s_waitcnt vmcnt(24)
    v_mfma_f32_16x16x32_bf16 a[48:51], v[48:51], v[76:79], a[48:51]
    v_mfma_f32_16x16x32_bf16 a[52:55], v[52:55], v[76:79], a[52:55]
    v_mfma_f32_16x16x32_bf16 a[56:59], v[56:59], v[76:79], a[56:59]
    v_mfma_f32_16x16x32_bf16 a[60:63], v[60:63], v[76:79], a[60:63]
    v_mfma_f32_16x16x16_bf16 v[180:183], v[160:161], a[136:137], 0
    v_mfma_f32_16x16x16_bf16 v[188:191], v[162:163], a[136:137], 0
    v_mfma_f32_16x16x16_bf16 v[184:187], v[164:165], a[138:139], 0
    v_mfma_f32_16x16x16_bf16 v[192:195], v[166:167], a[138:139], 0
    s_nop 5
    v_cvt_pk_bf16_f32 v196, v188, v188
    v_lshlrev_b32 v196, 16, v196
    v_add_f32 v196, 0x358637bd, v196
    v_cvt_pk_bf16_f32 v196, v196, v196
    v_lshlrev_b32 v196, 16, v196
    v_rcp_f32 v196, v196
    v_cvt_pk_bf16_f32 v197, v180, v181
    v_cvt_pk_bf16_f32 v198, v182, v183
    v_lshlrev_b32 v180, 16, v197
    v_and_b32 v181, 0xffff0000, v197
    v_lshlrev_b32 v182, 16, v198
    v_and_b32 v183, 0xffff0000, v198
    v_mul_f32 v180, v180, v196
    v_mul_f32 v181, v181, v196
    v_mul_f32 v182, v182, v196
    v_mul_f32 v183, v183, v196
    v_cvt_pk_bf16_f32 v176, v180, v181
    v_cvt_pk_bf16_f32 v177, v182, v183
    v_cvt_pk_bf16_f32 v204, v192, v192
    v_lshlrev_b32 v204, 16, v204
    v_add_f32 v204, 0x358637bd, v204
    v_cvt_pk_bf16_f32 v204, v204, v204
    v_lshlrev_b32 v204, 16, v204
    v_rcp_f32 v204, v204
    v_cvt_pk_bf16_f32 v205, v184, v185
    v_cvt_pk_bf16_f32 v206, v186, v187
    v_lshlrev_b32 v184, 16, v205
    v_and_b32 v185, 0xffff0000, v205
    v_lshlrev_b32 v186, 16, v206
    v_and_b32 v187, 0xffff0000, v206
    v_mul_f32 v184, v184, v204
    v_mul_f32 v185, v185, v204
    v_mul_f32 v186, v186, v204
    v_mul_f32 v187, v187, v204
    v_cvt_pk_bf16_f32 v178, v184, v185
    v_cvt_pk_bf16_f32 v179, v186, v187
    s_nop 1
    v_mfma_f32_16x16x32_bf16 a[64:67], a[224:227], v[176:179], a[64:67]
    v_mfma_f32_16x16x32_bf16 a[68:71], a[228:231], v[176:179], a[68:71]
    v_mfma_f32_16x16x32_bf16 a[72:75], a[232:235], v[176:179], a[72:75]
    v_mfma_f32_16x16x32_bf16 a[76:79], a[236:239], v[176:179], a[76:79]
    s_add_u32 s55, s36, 9216
    buffer_load_dwordx4 v[48:51], v1, s[28:31], s55 offen
    s_add_u32 s55, s37, 9216
    buffer_load_dwordx4 v[52:55], v1, s[28:31], s55 offen
    s_add_u32 s55, s38, 9216
    buffer_load_dwordx4 v[56:59], v1, s[28:31], s55 offen
    s_add_u32 s55, s39, 9216
    buffer_load_dwordx4 v[60:63], v1, s[28:31], s55 offen
    s_add_u32 s56, s40, 9216
    buffer_load_dwordx4 v[64:67], v1, s[28:31], s56 offen
    s_add_u32 s56, s41, 9216
    buffer_load_dwordx4 v[68:71], v1, s[28:31], s56 offen
    s_add_u32 s56, s42, 9216
    buffer_load_dwordx4 v[72:75], v1, s[28:31], s56 offen
    s_add_u32 s56, s43, 9216
    buffer_load_dwordx4 v[76:79], v1, s[28:31], s56 offen
    s_waitcnt vmcnt(27)
    v_mfma_f32_16x16x32_bf16 a[0:3], v[80:83], v[96:99], a[0:3]
    v_mfma_f32_16x16x32_bf16 a[4:7], v[84:87], v[96:99], a[4:7]
    v_mfma_f32_16x16x32_bf16 a[8:11], v[88:91], v[96:99], a[8:11]
    v_mfma_f32_16x16x32_bf16 a[12:15], v[92:95], v[96:99], a[12:15]
    s_waitcnt vmcnt(26)
    v_mfma_f32_16x16x32_bf16 a[16:19], v[80:83], v[100:103], a[16:19]
    v_mfma_f32_16x16x32_bf16 a[20:23], v[84:87], v[100:103], a[20:23]
    v_mfma_f32_16x16x32_bf16 a[24:27], v[88:91], v[100:103], a[24:27]
    v_mfma_f32_16x16x32_bf16 a[28:31], v[92:95], v[100:103], a[28:31]
    s_waitcnt vmcnt(25)
    v_mfma_f32_16x16x32_bf16 a[32:35], v[80:83], v[104:107], a[32:35]
    v_mfma_f32_16x16x32_bf16 a[36:39], v[84:87], v[104:107], a[36:39]
    v_mfma_f32_16x16x32_bf16 a[40:43], v[88:91], v[104:107], a[40:43]
    v_mfma_f32_16x16x32_bf16 a[44:47], v[92:95], v[104:107], a[44:47]
    s_waitcnt vmcnt(24)
    v_mfma_f32_16x16x32_bf16 a[48:51], v[80:83], v[108:111], a[48:51]
    v_mfma_f32_16x16x32_bf16 a[52:55], v[84:87], v[108:111], a[52:55]
    v_mfma_f32_16x16x32_bf16 a[56:59], v[88:91], v[108:111], a[56:59]
    v_mfma_f32_16x16x32_bf16 a[60:63], v[92:95], v[108:111], a[60:63]
    v_mfma_f32_16x16x16_bf16 v[180:183], v[160:161], a[152:153], 0
    v_mfma_f32_16x16x16_bf16 v[188:191], v[162:163], a[152:153], 0
    v_mfma_f32_16x16x16_bf16 v[184:187], v[164:165], a[154:155], 0
    v_mfma_f32_16x16x16_bf16 v[192:195], v[166:167], a[154:155], 0
    s_nop 5
    v_cvt_pk_bf16_f32 v196, v188, v188
    v_lshlrev_b32 v196, 16, v196
    v_add_f32 v196, 0x358637bd, v196
    v_cvt_pk_bf16_f32 v196, v196, v196
    v_lshlrev_b32 v196, 16, v196
    v_rcp_f32 v196, v196
    v_cvt_pk_bf16_f32 v197, v180, v181
    v_cvt_pk_bf16_f32 v198, v182, v183
    v_lshlrev_b32 v180, 16, v197
    v_and_b32 v181, 0xffff0000, v197
    v_lshlrev_b32 v182, 16, v198
    v_and_b32 v183, 0xffff0000, v198
    v_mul_f32 v180, v180, v196
    v_mul_f32 v181, v181, v196
    v_mul_f32 v182, v182, v196
    v_mul_f32 v183, v183, v196
    v_cvt_pk_bf16_f32 v176, v180, v181
    v_cvt_pk_bf16_f32 v177, v182, v183
    v_cvt_pk_bf16_f32 v204, v192, v192
    v_lshlrev_b32 v204, 16, v204
    v_add_f32 v204, 0x358637bd, v204
    v_cvt_pk_bf16_f32 v204, v204, v204
    v_lshlrev_b32 v204, 16, v204
    v_rcp_f32 v204, v204
    v_cvt_pk_bf16_f32 v205, v184, v185
    v_cvt_pk_bf16_f32 v206, v186, v187
    v_lshlrev_b32 v184, 16, v205
    v_and_b32 v185, 0xffff0000, v205
    v_lshlrev_b32 v186, 16, v206
    v_and_b32 v187, 0xffff0000, v206
    v_mul_f32 v184, v184, v204
    v_mul_f32 v185, v185, v204
    v_mul_f32 v186, v186, v204
    v_mul_f32 v187, v187, v204
    v_cvt_pk_bf16_f32 v178, v184, v185
    v_cvt_pk_bf16_f32 v179, v186, v187
    s_nop 1
    v_mfma_f32_16x16x32_bf16 a[80:83], a[224:227], v[176:179], a[80:83]
    v_mfma_f32_16x16x32_bf16 a[84:87], a[228:231], v[176:179], a[84:87]
    v_mfma_f32_16x16x32_bf16 a[88:91], a[232:235], v[176:179], a[88:91]
    v_mfma_f32_16x16x32_bf16 a[92:95], a[236:239], v[176:179], a[92:95]
    s_add_u32 s55, s36, 10240
    buffer_load_dwordx4 v[80:83], v1, s[28:31], s55 offen
    s_add_u32 s55, s37, 10240
    buffer_load_dwordx4 v[84:87], v1, s[28:31], s55 offen
    s_add_u32 s55, s38, 10240
    buffer_load_dwordx4 v[88:91], v1, s[28:31], s55 offen
    s_add_u32 s55, s39, 10240
    buffer_load_dwordx4 v[92:95], v1, s[28:31], s55 offen
    s_add_u32 s56, s40, 10240
    buffer_load_dwordx4 v[96:99], v1, s[28:31], s56 offen
    s_add_u32 s56, s41, 10240
    buffer_load_dwordx4 v[100:103], v1, s[28:31], s56 offen
    s_add_u32 s56, s42, 10240
    buffer_load_dwordx4 v[104:107], v1, s[28:31], s56 offen
    s_add_u32 s56, s43, 10240
    buffer_load_dwordx4 v[108:111], v1, s[28:31], s56 offen
    s_waitcnt vmcnt(27)
    v_mfma_f32_16x16x32_bf16 a[0:3], v[112:115], v[128:131], a[0:3]
    v_mfma_f32_16x16x32_bf16 a[4:7], v[116:119], v[128:131], a[4:7]
    v_mfma_f32_16x16x32_bf16 a[8:11], v[120:123], v[128:131], a[8:11]
    v_mfma_f32_16x16x32_bf16 a[12:15], v[124:127], v[128:131], a[12:15]
    s_waitcnt vmcnt(26)
    v_mfma_f32_16x16x32_bf16 a[16:19], v[112:115], v[132:135], a[16:19]
    v_mfma_f32_16x16x32_bf16 a[20:23], v[116:119], v[132:135], a[20:23]
    v_mfma_f32_16x16x32_bf16 a[24:27], v[120:123], v[132:135], a[24:27]
    v_mfma_f32_16x16x32_bf16 a[28:31], v[124:127], v[132:135], a[28:31]
    s_waitcnt vmcnt(25)
    v_mfma_f32_16x16x32_bf16 a[32:35], v[112:115], v[136:139], a[32:35]
    v_mfma_f32_16x16x32_bf16 a[36:39], v[116:119], v[136:139], a[36:39]
    v_mfma_f32_16x16x32_bf16 a[40:43], v[120:123], v[136:139], a[40:43]
    v_mfma_f32_16x16x32_bf16 a[44:47], v[124:127], v[136:139], a[44:47]
    s_waitcnt vmcnt(24)
    v_mfma_f32_16x16x32_bf16 a[48:51], v[112:115], v[140:143], a[48:51]
    v_mfma_f32_16x16x32_bf16 a[52:55], v[116:119], v[140:143], a[52:55]
    v_mfma_f32_16x16x32_bf16 a[56:59], v[120:123], v[140:143], a[56:59]
    v_mfma_f32_16x16x32_bf16 a[60:63], v[124:127], v[140:143], a[60:63]
    v_mfma_f32_16x16x16_bf16 v[180:183], v[160:161], a[168:169], 0
    v_mfma_f32_16x16x16_bf16 v[188:191], v[162:163], a[168:169], 0
    v_mfma_f32_16x16x16_bf16 v[184:187], v[164:165], a[170:171], 0
    v_mfma_f32_16x16x16_bf16 v[192:195], v[166:167], a[170:171], 0
    s_nop 5
    v_cvt_pk_bf16_f32 v196, v188, v188
    v_lshlrev_b32 v196, 16, v196
    v_add_f32 v196, 0x358637bd, v196
    v_cvt_pk_bf16_f32 v196, v196, v196
    v_lshlrev_b32 v196, 16, v196
    v_rcp_f32 v196, v196
    v_cvt_pk_bf16_f32 v197, v180, v181
    v_cvt_pk_bf16_f32 v198, v182, v183
    v_lshlrev_b32 v180, 16, v197
    v_and_b32 v181, 0xffff0000, v197
    v_lshlrev_b32 v182, 16, v198
    v_and_b32 v183, 0xffff0000, v198
    v_mul_f32 v180, v180, v196
    v_mul_f32 v181, v181, v196
    v_mul_f32 v182, v182, v196
    v_mul_f32 v183, v183, v196
    v_cvt_pk_bf16_f32 v176, v180, v181
    v_cvt_pk_bf16_f32 v177, v182, v183
    v_cvt_pk_bf16_f32 v204, v192, v192
    v_lshlrev_b32 v204, 16, v204
    v_add_f32 v204, 0x358637bd, v204
    v_cvt_pk_bf16_f32 v204, v204, v204
    v_lshlrev_b32 v204, 16, v204
    v_rcp_f32 v204, v204
    v_cvt_pk_bf16_f32 v205, v184, v185
    v_cvt_pk_bf16_f32 v206, v186, v187
    v_lshlrev_b32 v184, 16, v205
    v_and_b32 v185, 0xffff0000, v205
    v_lshlrev_b32 v186, 16, v206
    v_and_b32 v187, 0xffff0000, v206
    v_mul_f32 v184, v184, v204
    v_mul_f32 v185, v185, v204
    v_mul_f32 v186, v186, v204
    v_mul_f32 v187, v187, v204
    v_cvt_pk_bf16_f32 v178, v184, v185
    v_cvt_pk_bf16_f32 v179, v186, v187
    s_nop 1
    v_mfma_f32_16x16x32_bf16 a[96:99], a[224:227], v[176:179], a[96:99]
    v_mfma_f32_16x16x32_bf16 a[100:103], a[228:231], v[176:179], a[100:103]
    v_mfma_f32_16x16x32_bf16 a[104:107], a[232:235], v[176:179], a[104:107]
    v_mfma_f32_16x16x32_bf16 a[108:111], a[236:239], v[176:179], a[108:111]
    s_add_u32 s55, s36, 11264
    buffer_load_dwordx4 v[112:115], v1, s[28:31], s55 offen
    s_add_u32 s55, s37, 11264
    buffer_load_dwordx4 v[116:119], v1, s[28:31], s55 offen
    s_add_u32 s55, s38, 11264
    buffer_load_dwordx4 v[120:123], v1, s[28:31], s55 offen
    s_add_u32 s55, s39, 11264
    buffer_load_dwordx4 v[124:127], v1, s[28:31], s55 offen
    s_add_u32 s56, s40, 11264
    buffer_load_dwordx4 v[128:131], v1, s[28:31], s56 offen
    s_add_u32 s56, s41, 11264
    buffer_load_dwordx4 v[132:135], v1, s[28:31], s56 offen
    s_add_u32 s56, s42, 11264
    buffer_load_dwordx4 v[136:139], v1, s[28:31], s56 offen
    s_add_u32 s56, s43, 11264
    buffer_load_dwordx4 v[140:143], v1, s[28:31], s56 offen
    s_waitcnt vmcnt(27)
    v_mfma_f32_16x16x32_bf16 a[0:3], v[16:19], v[32:35], a[0:3]
    v_mfma_f32_16x16x32_bf16 a[4:7], v[20:23], v[32:35], a[4:7]
    v_mfma_f32_16x16x32_bf16 a[8:11], v[24:27], v[32:35], a[8:11]
    v_mfma_f32_16x16x32_bf16 a[12:15], v[28:31], v[32:35], a[12:15]
    s_waitcnt vmcnt(26)
    v_mfma_f32_16x16x32_bf16 a[16:19], v[16:19], v[36:39], a[16:19]
    v_mfma_f32_16x16x32_bf16 a[20:23], v[20:23], v[36:39], a[20:23]
    v_mfma_f32_16x16x32_bf16 a[24:27], v[24:27], v[36:39], a[24:27]
    v_mfma_f32_16x16x32_bf16 a[28:31], v[28:31], v[36:39], a[28:31]
    s_waitcnt vmcnt(25)
    v_mfma_f32_16x16x32_bf16 a[32:35], v[16:19], v[40:43], a[32:35]
    v_mfma_f32_16x16x32_bf16 a[36:39], v[20:23], v[40:43], a[36:39]
    v_mfma_f32_16x16x32_bf16 a[40:43], v[24:27], v[40:43], a[40:43]
    v_mfma_f32_16x16x32_bf16 a[44:47], v[28:31], v[40:43], a[44:47]
    s_waitcnt vmcnt(24)
    v_mfma_f32_16x16x32_bf16 a[48:51], v[16:19], v[44:47], a[48:51]
    v_mfma_f32_16x16x32_bf16 a[52:55], v[20:23], v[44:47], a[52:55]
    v_mfma_f32_16x16x32_bf16 a[56:59], v[24:27], v[44:47], a[56:59]
    v_mfma_f32_16x16x32_bf16 a[60:63], v[28:31], v[44:47], a[60:63]
    v_mfma_f32_16x16x16_bf16 v[180:183], v[160:161], a[184:185], 0
    v_mfma_f32_16x16x16_bf16 v[188:191], v[162:163], a[184:185], 0
    v_mfma_f32_16x16x16_bf16 v[184:187], v[164:165], a[186:187], 0
    v_mfma_f32_16x16x16_bf16 v[192:195], v[166:167], a[186:187], 0
    s_nop 5
    v_cvt_pk_bf16_f32 v196, v188, v188
    v_lshlrev_b32 v196, 16, v196
    v_add_f32 v196, 0x358637bd, v196
    v_cvt_pk_bf16_f32 v196, v196, v196
    v_lshlrev_b32 v196, 16, v196
    v_rcp_f32 v196, v196
    v_cvt_pk_bf16_f32 v197, v180, v181
    v_cvt_pk_bf16_f32 v198, v182, v183
    v_lshlrev_b32 v180, 16, v197
    v_and_b32 v181, 0xffff0000, v197
    v_lshlrev_b32 v182, 16, v198
    v_and_b32 v183, 0xffff0000, v198
    v_mul_f32 v180, v180, v196
    v_mul_f32 v181, v181, v196
    v_mul_f32 v182, v182, v196
    v_mul_f32 v183, v183, v196
    v_cvt_pk_bf16_f32 v176, v180, v181
    v_cvt_pk_bf16_f32 v177, v182, v183
    v_cvt_pk_bf16_f32 v204, v192, v192
    v_lshlrev_b32 v204, 16, v204
    v_add_f32 v204, 0x358637bd, v204
    v_cvt_pk_bf16_f32 v204, v204, v204
    v_lshlrev_b32 v204, 16, v204
    v_rcp_f32 v204, v204
    v_cvt_pk_bf16_f32 v205, v184, v185
    v_cvt_pk_bf16_f32 v206, v186, v187
    v_lshlrev_b32 v184, 16, v205
    v_and_b32 v185, 0xffff0000, v205
    v_lshlrev_b32 v186, 16, v206
    v_and_b32 v187, 0xffff0000, v206
    v_mul_f32 v184, v184, v204
    v_mul_f32 v185, v185, v204
    v_mul_f32 v186, v186, v204
    v_mul_f32 v187, v187, v204
    v_cvt_pk_bf16_f32 v178, v184, v185
    v_cvt_pk_bf16_f32 v179, v186, v187
    s_nop 1
    v_mfma_f32_16x16x32_bf16 a[112:115], a[224:227], v[176:179], a[112:115]
    v_mfma_f32_16x16x32_bf16 a[116:119], a[228:231], v[176:179], a[116:119]
    v_mfma_f32_16x16x32_bf16 a[120:123], a[232:235], v[176:179], a[120:123]
    v_mfma_f32_16x16x32_bf16 a[124:127], a[236:239], v[176:179], a[124:127]
    s_add_u32 s55, s36, 12288
    buffer_load_dwordx4 v[16:19], v1, s[28:31], s55 offen
    s_add_u32 s55, s37, 12288
    buffer_load_dwordx4 v[20:23], v1, s[28:31], s55 offen
    s_add_u32 s55, s38, 12288
    buffer_load_dwordx4 v[24:27], v1, s[28:31], s55 offen
    s_add_u32 s55, s39, 12288
    buffer_load_dwordx4 v[28:31], v1, s[28:31], s55 offen
    s_add_u32 s56, s40, 12288
    buffer_load_dwordx4 v[32:35], v1, s[28:31], s56 offen
    s_add_u32 s56, s41, 12288
    buffer_load_dwordx4 v[36:39], v1, s[28:31], s56 offen
    s_add_u32 s56, s42, 12288
    buffer_load_dwordx4 v[40:43], v1, s[28:31], s56 offen
    s_add_u32 s56, s43, 12288
    buffer_load_dwordx4 v[44:47], v1, s[28:31], s56 offen
    s_waitcnt vmcnt(27)
    v_mfma_f32_16x16x32_bf16 a[0:3], v[48:51], v[64:67], a[0:3]
    v_mfma_f32_16x16x32_bf16 a[4:7], v[52:55], v[64:67], a[4:7]
    v_mfma_f32_16x16x32_bf16 a[8:11], v[56:59], v[64:67], a[8:11]
    v_mfma_f32_16x16x32_bf16 a[12:15], v[60:63], v[64:67], a[12:15]
    s_waitcnt vmcnt(26)
    v_mfma_f32_16x16x32_bf16 a[16:19], v[48:51], v[68:71], a[16:19]
    v_mfma_f32_16x16x32_bf16 a[20:23], v[52:55], v[68:71], a[20:23]
    v_mfma_f32_16x16x32_bf16 a[24:27], v[56:59], v[68:71], a[24:27]
    v_mfma_f32_16x16x32_bf16 a[28:31], v[60:63], v[68:71], a[28:31]
    s_waitcnt vmcnt(25)
    v_mfma_f32_16x16x32_bf16 a[32:35], v[48:51], v[72:75], a[32:35]
    v_mfma_f32_16x16x32_bf16 a[36:39], v[52:55], v[72:75], a[36:39]
    v_mfma_f32_16x16x32_bf16 a[40:43], v[56:59], v[72:75], a[40:43]
    v_mfma_f32_16x16x32_bf16 a[44:47], v[60:63], v[72:75], a[44:47]
    s_waitcnt vmcnt(24)
    v_mfma_f32_16x16x32_bf16 a[48:51], v[48:51], v[76:79], a[48:51]
    v_mfma_f32_16x16x32_bf16 a[52:55], v[52:55], v[76:79], a[52:55]
    v_mfma_f32_16x16x32_bf16 a[56:59], v[56:59], v[76:79], a[56:59]
    v_mfma_f32_16x16x32_bf16 a[60:63], v[60:63], v[76:79], a[60:63]
    v_mfma_f32_16x16x16_bf16 v[180:183], v[168:169], a[140:141], 0
    v_mfma_f32_16x16x16_bf16 v[188:191], v[170:171], a[140:141], 0
    v_mfma_f32_16x16x16_bf16 v[184:187], v[172:173], a[142:143], 0
    v_mfma_f32_16x16x16_bf16 v[192:195], v[174:175], a[142:143], 0
    s_nop 5
    v_cvt_pk_bf16_f32 v196, v188, v188
    v_lshlrev_b32 v196, 16, v196
    v_add_f32 v196, 0x358637bd, v196
    v_cvt_pk_bf16_f32 v196, v196, v196
    v_lshlrev_b32 v196, 16, v196
    v_rcp_f32 v196, v196
    v_cvt_pk_bf16_f32 v197, v180, v181
    v_cvt_pk_bf16_f32 v198, v182, v183
    v_lshlrev_b32 v180, 16, v197
    v_and_b32 v181, 0xffff0000, v197
    v_lshlrev_b32 v182, 16, v198
    v_and_b32 v183, 0xffff0000, v198
    v_mul_f32 v180, v180, v196
    v_mul_f32 v181, v181, v196
    v_mul_f32 v182, v182, v196
    v_mul_f32 v183, v183, v196
    v_cvt_pk_bf16_f32 v176, v180, v181
    v_cvt_pk_bf16_f32 v177, v182, v183
    v_cvt_pk_bf16_f32 v204, v192, v192
    v_lshlrev_b32 v204, 16, v204
    v_add_f32 v204, 0x358637bd, v204
    v_cvt_pk_bf16_f32 v204, v204, v204
    v_lshlrev_b32 v204, 16, v204
    v_rcp_f32 v204, v204
    v_cvt_pk_bf16_f32 v205, v184, v185
    v_cvt_pk_bf16_f32 v206, v186, v187
    v_lshlrev_b32 v184, 16, v205
    v_and_b32 v185, 0xffff0000, v205
    v_lshlrev_b32 v186, 16, v206
    v_and_b32 v187, 0xffff0000, v206
    v_mul_f32 v184, v184, v204
    v_mul_f32 v185, v185, v204
    v_mul_f32 v186, v186, v204
    v_mul_f32 v187, v187, v204
    v_cvt_pk_bf16_f32 v178, v184, v185
    v_cvt_pk_bf16_f32 v179, v186, v187
    s_nop 1
    v_mfma_f32_16x16x32_bf16 a[64:67], a[240:243], v[176:179], a[64:67]
    v_mfma_f32_16x16x32_bf16 a[68:71], a[244:247], v[176:179], a[68:71]
    v_mfma_f32_16x16x32_bf16 a[72:75], a[248:251], v[176:179], a[72:75]
    v_mfma_f32_16x16x32_bf16 a[76:79], a[252:255], v[176:179], a[76:79]
    s_add_u32 s55, s36, 13312
    buffer_load_dwordx4 v[48:51], v1, s[28:31], s55 offen
    s_add_u32 s55, s37, 13312
    buffer_load_dwordx4 v[52:55], v1, s[28:31], s55 offen
    s_add_u32 s55, s38, 13312
    buffer_load_dwordx4 v[56:59], v1, s[28:31], s55 offen
    s_add_u32 s55, s39, 13312
    buffer_load_dwordx4 v[60:63], v1, s[28:31], s55 offen
    s_add_u32 s56, s40, 13312
    buffer_load_dwordx4 v[64:67], v1, s[28:31], s56 offen
    s_add_u32 s56, s41, 13312
    buffer_load_dwordx4 v[68:71], v1, s[28:31], s56 offen
    s_add_u32 s56, s42, 13312
    buffer_load_dwordx4 v[72:75], v1, s[28:31], s56 offen
    s_add_u32 s56, s43, 13312
    buffer_load_dwordx4 v[76:79], v1, s[28:31], s56 offen
    s_waitcnt vmcnt(27)
    v_mfma_f32_16x16x32_bf16 a[0:3], v[80:83], v[96:99], a[0:3]
    v_mfma_f32_16x16x32_bf16 a[4:7], v[84:87], v[96:99], a[4:7]
    v_mfma_f32_16x16x32_bf16 a[8:11], v[88:91], v[96:99], a[8:11]
    v_mfma_f32_16x16x32_bf16 a[12:15], v[92:95], v[96:99], a[12:15]
    s_waitcnt vmcnt(26)
    v_mfma_f32_16x16x32_bf16 a[16:19], v[80:83], v[100:103], a[16:19]
    v_mfma_f32_16x16x32_bf16 a[20:23], v[84:87], v[100:103], a[20:23]
    v_mfma_f32_16x16x32_bf16 a[24:27], v[88:91], v[100:103], a[24:27]
    v_mfma_f32_16x16x32_bf16 a[28:31], v[92:95], v[100:103], a[28:31]
    s_waitcnt vmcnt(25)
    v_mfma_f32_16x16x32_bf16 a[32:35], v[80:83], v[104:107], a[32:35]
    v_mfma_f32_16x16x32_bf16 a[36:39], v[84:87], v[104:107], a[36:39]
    v_mfma_f32_16x16x32_bf16 a[40:43], v[88:91], v[104:107], a[40:43]
    v_mfma_f32_16x16x32_bf16 a[44:47], v[92:95], v[104:107], a[44:47]
    s_waitcnt vmcnt(24)
    v_mfma_f32_16x16x32_bf16 a[48:51], v[80:83], v[108:111], a[48:51]
    v_mfma_f32_16x16x32_bf16 a[52:55], v[84:87], v[108:111], a[52:55]
    v_mfma_f32_16x16x32_bf16 a[56:59], v[88:91], v[108:111], a[56:59]
    v_mfma_f32_16x16x32_bf16 a[60:63], v[92:95], v[108:111], a[60:63]
    v_mfma_f32_16x16x16_bf16 v[180:183], v[168:169], a[156:157], 0
    v_mfma_f32_16x16x16_bf16 v[188:191], v[170:171], a[156:157], 0
    v_mfma_f32_16x16x16_bf16 v[184:187], v[172:173], a[158:159], 0
    v_mfma_f32_16x16x16_bf16 v[192:195], v[174:175], a[158:159], 0
    s_nop 5
    v_cvt_pk_bf16_f32 v196, v188, v188
    v_lshlrev_b32 v196, 16, v196
    v_add_f32 v196, 0x358637bd, v196
    v_cvt_pk_bf16_f32 v196, v196, v196
    v_lshlrev_b32 v196, 16, v196
    v_rcp_f32 v196, v196
    v_cvt_pk_bf16_f32 v197, v180, v181
    v_cvt_pk_bf16_f32 v198, v182, v183
    v_lshlrev_b32 v180, 16, v197
    v_and_b32 v181, 0xffff0000, v197
    v_lshlrev_b32 v182, 16, v198
    v_and_b32 v183, 0xffff0000, v198
    v_mul_f32 v180, v180, v196
    v_mul_f32 v181, v181, v196
    v_mul_f32 v182, v182, v196
    v_mul_f32 v183, v183, v196
    v_cvt_pk_bf16_f32 v176, v180, v181
    v_cvt_pk_bf16_f32 v177, v182, v183
    v_cvt_pk_bf16_f32 v204, v192, v192
    v_lshlrev_b32 v204, 16, v204
    v_add_f32 v204, 0x358637bd, v204
    v_cvt_pk_bf16_f32 v204, v204, v204
    v_lshlrev_b32 v204, 16, v204
    v_rcp_f32 v204, v204
    v_cvt_pk_bf16_f32 v205, v184, v185
    v_cvt_pk_bf16_f32 v206, v186, v187
    v_lshlrev_b32 v184, 16, v205
    v_and_b32 v185, 0xffff0000, v205
    v_lshlrev_b32 v186, 16, v206
    v_and_b32 v187, 0xffff0000, v206
    v_mul_f32 v184, v184, v204
    v_mul_f32 v185, v185, v204
    v_mul_f32 v186, v186, v204
    v_mul_f32 v187, v187, v204
    v_cvt_pk_bf16_f32 v178, v184, v185
    v_cvt_pk_bf16_f32 v179, v186, v187
    s_nop 1
    v_mfma_f32_16x16x32_bf16 a[80:83], a[240:243], v[176:179], a[80:83]
    v_mfma_f32_16x16x32_bf16 a[84:87], a[244:247], v[176:179], a[84:87]
    v_mfma_f32_16x16x32_bf16 a[88:91], a[248:251], v[176:179], a[88:91]
    v_mfma_f32_16x16x32_bf16 a[92:95], a[252:255], v[176:179], a[92:95]
    s_waitcnt vmcnt(19)
    v_mfma_f32_16x16x32_bf16 a[0:3], v[112:115], v[128:131], a[0:3]
    v_mfma_f32_16x16x32_bf16 a[4:7], v[116:119], v[128:131], a[4:7]
    v_mfma_f32_16x16x32_bf16 a[8:11], v[120:123], v[128:131], a[8:11]
    v_mfma_f32_16x16x32_bf16 a[12:15], v[124:127], v[128:131], a[12:15]
    s_waitcnt vmcnt(18)
    v_mfma_f32_16x16x32_bf16 a[16:19], v[112:115], v[132:135], a[16:19]
    v_mfma_f32_16x16x32_bf16 a[20:23], v[116:119], v[132:135], a[20:23]
    v_mfma_f32_16x16x32_bf16 a[24:27], v[120:123], v[132:135], a[24:27]
    v_mfma_f32_16x16x32_bf16 a[28:31], v[124:127], v[132:135], a[28:31]
    s_waitcnt vmcnt(17)
    v_mfma_f32_16x16x32_bf16 a[32:35], v[112:115], v[136:139], a[32:35]
    v_mfma_f32_16x16x32_bf16 a[36:39], v[116:119], v[136:139], a[36:39]
    v_mfma_f32_16x16x32_bf16 a[40:43], v[120:123], v[136:139], a[40:43]
    v_mfma_f32_16x16x32_bf16 a[44:47], v[124:127], v[136:139], a[44:47]
    s_waitcnt vmcnt(16)
    v_mfma_f32_16x16x32_bf16 a[48:51], v[112:115], v[140:143], a[48:51]
    v_mfma_f32_16x16x32_bf16 a[52:55], v[116:119], v[140:143], a[52:55]
    v_mfma_f32_16x16x32_bf16 a[56:59], v[120:123], v[140:143], a[56:59]
    v_mfma_f32_16x16x32_bf16 a[60:63], v[124:127], v[140:143], a[60:63]
    v_mfma_f32_16x16x16_bf16 v[180:183], v[168:169], a[172:173], 0
    v_mfma_f32_16x16x16_bf16 v[188:191], v[170:171], a[172:173], 0
    v_mfma_f32_16x16x16_bf16 v[184:187], v[172:173], a[174:175], 0
    v_mfma_f32_16x16x16_bf16 v[192:195], v[174:175], a[174:175], 0
    s_nop 5
    v_cvt_pk_bf16_f32 v196, v188, v188
    v_lshlrev_b32 v196, 16, v196
    v_add_f32 v196, 0x358637bd, v196
    v_cvt_pk_bf16_f32 v196, v196, v196
    v_lshlrev_b32 v196, 16, v196
    v_rcp_f32 v196, v196
    v_cvt_pk_bf16_f32 v197, v180, v181
    v_cvt_pk_bf16_f32 v198, v182, v183
    v_lshlrev_b32 v180, 16, v197
    v_and_b32 v181, 0xffff0000, v197
    v_lshlrev_b32 v182, 16, v198
    v_and_b32 v183, 0xffff0000, v198
    v_mul_f32 v180, v180, v196
    v_mul_f32 v181, v181, v196
    v_mul_f32 v182, v182, v196
    v_mul_f32 v183, v183, v196
    v_cvt_pk_bf16_f32 v176, v180, v181
    v_cvt_pk_bf16_f32 v177, v182, v183
    v_cvt_pk_bf16_f32 v204, v192, v192
    v_lshlrev_b32 v204, 16, v204
    v_add_f32 v204, 0x358637bd, v204
    v_cvt_pk_bf16_f32 v204, v204, v204
    v_lshlrev_b32 v204, 16, v204
    v_rcp_f32 v204, v204
    v_cvt_pk_bf16_f32 v205, v184, v185
    v_cvt_pk_bf16_f32 v206, v186, v187
    v_lshlrev_b32 v184, 16, v205
    v_and_b32 v185, 0xffff0000, v205
    v_lshlrev_b32 v186, 16, v206
    v_and_b32 v187, 0xffff0000, v206
    v_mul_f32 v184, v184, v204
    v_mul_f32 v185, v185, v204
    v_mul_f32 v186, v186, v204
    v_mul_f32 v187, v187, v204
    v_cvt_pk_bf16_f32 v178, v184, v185
    v_cvt_pk_bf16_f32 v179, v186, v187
    s_nop 1
    v_mfma_f32_16x16x32_bf16 a[96:99], a[240:243], v[176:179], a[96:99]
    v_mfma_f32_16x16x32_bf16 a[100:103], a[244:247], v[176:179], a[100:103]
    v_mfma_f32_16x16x32_bf16 a[104:107], a[248:251], v[176:179], a[104:107]
    v_mfma_f32_16x16x32_bf16 a[108:111], a[252:255], v[176:179], a[108:111]
    s_waitcnt vmcnt(11)
    v_mfma_f32_16x16x32_bf16 a[0:3], v[16:19], v[32:35], a[0:3]
    v_mfma_f32_16x16x32_bf16 a[4:7], v[20:23], v[32:35], a[4:7]
    v_mfma_f32_16x16x32_bf16 a[8:11], v[24:27], v[32:35], a[8:11]
    v_mfma_f32_16x16x32_bf16 a[12:15], v[28:31], v[32:35], a[12:15]
    s_waitcnt vmcnt(10)
    v_mfma_f32_16x16x32_bf16 a[16:19], v[16:19], v[36:39], a[16:19]
    v_mfma_f32_16x16x32_bf16 a[20:23], v[20:23], v[36:39], a[20:23]
    v_mfma_f32_16x16x32_bf16 a[24:27], v[24:27], v[36:39], a[24:27]
    v_mfma_f32_16x16x32_bf16 a[28:31], v[28:31], v[36:39], a[28:31]
    s_waitcnt vmcnt(9)
    v_mfma_f32_16x16x32_bf16 a[32:35], v[16:19], v[40:43], a[32:35]
    v_mfma_f32_16x16x32_bf16 a[36:39], v[20:23], v[40:43], a[36:39]
    v_mfma_f32_16x16x32_bf16 a[40:43], v[24:27], v[40:43], a[40:43]
    v_mfma_f32_16x16x32_bf16 a[44:47], v[28:31], v[40:43], a[44:47]
    s_waitcnt vmcnt(8)
    v_mfma_f32_16x16x32_bf16 a[48:51], v[16:19], v[44:47], a[48:51]
    v_mfma_f32_16x16x32_bf16 a[52:55], v[20:23], v[44:47], a[52:55]
    v_mfma_f32_16x16x32_bf16 a[56:59], v[24:27], v[44:47], a[56:59]
    v_mfma_f32_16x16x32_bf16 a[60:63], v[28:31], v[44:47], a[60:63]
    v_mfma_f32_16x16x16_bf16 v[180:183], v[168:169], a[188:189], 0
    v_mfma_f32_16x16x16_bf16 v[188:191], v[170:171], a[188:189], 0
    v_mfma_f32_16x16x16_bf16 v[184:187], v[172:173], a[190:191], 0
    v_mfma_f32_16x16x16_bf16 v[192:195], v[174:175], a[190:191], 0
    s_nop 5
    v_cvt_pk_bf16_f32 v196, v188, v188
    v_lshlrev_b32 v196, 16, v196
    v_add_f32 v196, 0x358637bd, v196
    v_cvt_pk_bf16_f32 v196, v196, v196
    v_lshlrev_b32 v196, 16, v196
    v_rcp_f32 v196, v196
    v_cvt_pk_bf16_f32 v197, v180, v181
    v_cvt_pk_bf16_f32 v198, v182, v183
    v_lshlrev_b32 v180, 16, v197
    v_and_b32 v181, 0xffff0000, v197
    v_lshlrev_b32 v182, 16, v198
    v_and_b32 v183, 0xffff0000, v198
    v_mul_f32 v180, v180, v196
    v_mul_f32 v181, v181, v196
    v_mul_f32 v182, v182, v196
    v_mul_f32 v183, v183, v196
    v_cvt_pk_bf16_f32 v176, v180, v181
    v_cvt_pk_bf16_f32 v177, v182, v183
    v_cvt_pk_bf16_f32 v204, v192, v192
    v_lshlrev_b32 v204, 16, v204
    v_add_f32 v204, 0x358637bd, v204
    v_cvt_pk_bf16_f32 v204, v204, v204
    v_lshlrev_b32 v204, 16, v204
    v_rcp_f32 v204, v204
    v_cvt_pk_bf16_f32 v205, v184, v185
    v_cvt_pk_bf16_f32 v206, v186, v187
    v_lshlrev_b32 v184, 16, v205
    v_and_b32 v185, 0xffff0000, v205
    v_lshlrev_b32 v186, 16, v206
    v_and_b32 v187, 0xffff0000, v206
    v_mul_f32 v184, v184, v204
    v_mul_f32 v185, v185, v204
    v_mul_f32 v186, v186, v204
    v_mul_f32 v187, v187, v204
    v_cvt_pk_bf16_f32 v178, v184, v185
    v_cvt_pk_bf16_f32 v179, v186, v187
    s_nop 1
    v_mfma_f32_16x16x32_bf16 a[112:115], a[240:243], v[176:179], a[112:115]
    v_mfma_f32_16x16x32_bf16 a[116:119], a[244:247], v[176:179], a[116:119]
    v_mfma_f32_16x16x32_bf16 a[120:123], a[248:251], v[176:179], a[120:123]
    v_mfma_f32_16x16x32_bf16 a[124:127], a[252:255], v[176:179], a[124:127]
    s_waitcnt vmcnt(3)
    v_mfma_f32_16x16x32_bf16 a[0:3], v[48:51], v[64:67], a[0:3]
    v_mfma_f32_16x16x32_bf16 a[4:7], v[52:55], v[64:67], a[4:7]
    v_mfma_f32_16x16x32_bf16 a[8:11], v[56:59], v[64:67], a[8:11]
    v_mfma_f32_16x16x32_bf16 a[12:15], v[60:63], v[64:67], a[12:15]
    s_waitcnt vmcnt(2)
    v_mfma_f32_16x16x32_bf16 a[16:19], v[48:51], v[68:71], a[16:19]
    v_mfma_f32_16x16x32_bf16 a[20:23], v[52:55], v[68:71], a[20:23]
    v_mfma_f32_16x16x32_bf16 a[24:27], v[56:59], v[68:71], a[24:27]
    v_mfma_f32_16x16x32_bf16 a[28:31], v[60:63], v[68:71], a[28:31]
    s_waitcnt vmcnt(1)
    v_mfma_f32_16x16x32_bf16 a[32:35], v[48:51], v[72:75], a[32:35]
    v_mfma_f32_16x16x32_bf16 a[36:39], v[52:55], v[72:75], a[36:39]
    v_mfma_f32_16x16x32_bf16 a[40:43], v[56:59], v[72:75], a[40:43]
    v_mfma_f32_16x16x32_bf16 a[44:47], v[60:63], v[72:75], a[44:47]
    s_waitcnt vmcnt(0)
    v_mfma_f32_16x16x32_bf16 a[48:51], v[48:51], v[76:79], a[48:51]
    v_mfma_f32_16x16x32_bf16 a[52:55], v[52:55], v[76:79], a[52:55]
    v_mfma_f32_16x16x32_bf16 a[56:59], v[56:59], v[76:79], a[56:59]
    v_mfma_f32_16x16x32_bf16 a[60:63], v[60:63], v[76:79], a[60:63]
    s_lshl_b32 s53, s34, 15
    v_add_u32 v5, s53, v1
    s_lshl_b32 s54, s34, 12
    v_add_u32 v6, s54, v1
    s_cmp_eq_u32 s34, 0
    s_cbranch_scc1 K2_WSKIP0
    ds_write_b128 v5, a[0:3] offset:0
    ds_write_b128 v5, a[4:7] offset:1024
    ds_write_b128 v5, a[8:11] offset:2048
    ds_write_b128 v5, a[12:15] offset:3072
    ds_write_b128 v5, a[64:67] offset:16384
    ds_write_b128 v5, a[68:71] offset:17408
    ds_write_b128 v5, a[72:75] offset:18432
    ds_write_b128 v5, a[76:79] offset:19456
K2_WSKIP0:
    s_nop 1
    s_cmp_eq_u32 s34, 1
    s_cbranch_scc1 K2_WSKIP1
    s_nop 4
    ds_write_b128 v5, a[16:19] offset:4096
    ds_write_b128 v5, a[20:23] offset:5120
    ds_write_b128 v5, a[24:27] offset:6144
    ds_write_b128 v5, a[28:31] offset:7168
    ds_write_b128 v5, a[80:83] offset:20480
    ds_write_b128 v5, a[84:87] offset:21504
    ds_write_b128 v5, a[88:91] offset:22528
    ds_write_b128 v5, a[92:95] offset:23552
    s_waitcnt lgkmcnt(15)
K2_WSKIP1:
    s_nop 1
    s_cmp_eq_u32 s34, 2
    s_cbranch_scc1 K2_WSKIP2
    s_nop 4
    ds_write_b128 v5, a[32:35] offset:8192
    s_waitcnt lgkmcnt(15)
    ds_write_b128 v5, a[36:39] offset:9216
    s_waitcnt lgkmcnt(15)
    ds_write_b128 v5, a[40:43] offset:10240
    s_waitcnt lgkmcnt(15)
    ds_write_b128 v5, a[44:47] offset:11264
    s_waitcnt lgkmcnt(15)
    ds_write_b128 v5, a[96:99] offset:24576
    s_waitcnt lgkmcnt(15)
    ds_write_b128 v5, a[100:103] offset:25600
    s_waitcnt lgkmcnt(15)
    ds_write_b128 v5, a[104:107] offset:26624
    s_waitcnt lgkmcnt(15)
    ds_write_b128 v5, a[108:111] offset:27648
    s_waitcnt lgkmcnt(15)
K2_WSKIP2:
    s_nop 1
    s_cmp_eq_u32 s34, 3
    s_cbranch_scc1 K2_WSKIP3
    s_nop 4
    ds_write_b128 v5, a[48:51] offset:12288
    s_waitcnt lgkmcnt(15)
    ds_write_b128 v5, a[52:55] offset:13312
    s_waitcnt lgkmcnt(15)
    ds_write_b128 v5, a[56:59] offset:14336
    s_waitcnt lgkmcnt(15)
    ds_write_b128 v5, a[60:63] offset:15360
    s_waitcnt lgkmcnt(15)
    ds_write_b128 v5, a[112:115] offset:28672
    s_waitcnt lgkmcnt(15)
    ds_write_b128 v5, a[116:119] offset:29696
    s_waitcnt lgkmcnt(15)
    ds_write_b128 v5, a[120:123] offset:30720
    s_waitcnt lgkmcnt(15)
    ds_write_b128 v5, a[124:127] offset:31744
    s_waitcnt lgkmcnt(15)
K2_WSKIP3:
    s_waitcnt lgkmcnt(0)
    s_barrier
    s_cmp_lg_u32 s34, 0
    s_cbranch_scc1 K2_OWN0
    s_nop 4
    v_accvgpr_read_b32 v180, a0
    v_accvgpr_read_b32 v181, a1
    v_accvgpr_read_b32 v182, a2
    v_accvgpr_read_b32 v183, a3
    v_accvgpr_read_b32 v184, a4
    v_accvgpr_read_b32 v185, a5
    v_accvgpr_read_b32 v186, a6
    v_accvgpr_read_b32 v187, a7
    v_accvgpr_read_b32 v188, a8
    v_accvgpr_read_b32 v189, a9
    v_accvgpr_read_b32 v190, a10
    v_accvgpr_read_b32 v191, a11
    v_accvgpr_read_b32 v192, a12
    v_accvgpr_read_b32 v193, a13
    v_accvgpr_read_b32 v194, a14
    v_accvgpr_read_b32 v195, a15
    v_accvgpr_read_b32 v196, a64
    v_accvgpr_read_b32 v197, a65
    v_accvgpr_read_b32 v198, a66
    v_accvgpr_read_b32 v199, a67
    v_accvgpr_read_b32 v200, a68
    v_accvgpr_read_b32 v201, a69
    v_accvgpr_read_b32 v202, a70
    v_accvgpr_read_b32 v203, a71
    v_accvgpr_read_b32 v204, a72
    v_accvgpr_read_b32 v205, a73
    v_accvgpr_read_b32 v206, a74
    v_accvgpr_read_b32 v207, a75
    v_accvgpr_read_b32 v208, a76
    v_accvgpr_read_b32 v209, a77
    v_accvgpr_read_b32 v210, a78
    v_accvgpr_read_b32 v211, a79
K2_OWN0:
    s_nop 1
    s_cmp_lg_u32 s34, 1
    s_cbranch_scc1 K2_OWN1
    s_nop 4
    v_accvgpr_read_b32 v180, a16
    v_accvgpr_read_b32 v181, a17
    v_accvgpr_read_b32 v182, a18
    v_accvgpr_read_b32 v183, a19
    v_accvgpr_read_b32 v184, a20
    v_accvgpr_read_b32 v185, a21
    v_accvgpr_read_b32 v186, a22
    v_accvgpr_read_b32 v187, a23
    v_accvgpr_read_b32 v188, a24
    v_accvgpr_read_b32 v189, a25
    v_accvgpr_read_b32 v190, a26
    v_accvgpr_read_b32 v191, a27
    v_accvgpr_read_b32 v192, a28
    v_accvgpr_read_b32 v193, a29
    v_accvgpr_read_b32 v194, a30
    v_accvgpr_read_b32 v195, a31
    v_accvgpr_read_b32 v196, a80
    v_accvgpr_read_b32 v197, a81
    v_accvgpr_read_b32 v198, a82
    v_accvgpr_read_b32 v199, a83
    v_accvgpr_read_b32 v200, a84
    v_accvgpr_read_b32 v201, a85
    v_accvgpr_read_b32 v202, a86
    v_accvgpr_read_b32 v203, a87
    v_accvgpr_read_b32 v204, a88
    v_accvgpr_read_b32 v205, a89
    v_accvgpr_read_b32 v206, a90
    v_accvgpr_read_b32 v207, a91
    v_accvgpr_read_b32 v208, a92
    v_accvgpr_read_b32 v209, a93
    v_accvgpr_read_b32 v210, a94
    v_accvgpr_read_b32 v211, a95
K2_OWN1:
    s_nop 1
    s_cmp_lg_u32 s34, 2
    s_cbranch_scc1 K2_OWN2
    s_nop 4
    v_accvgpr_read_b32 v180, a32
    v_accvgpr_read_b32 v181, a33
    v_accvgpr_read_b32 v182, a34
    v_accvgpr_read_b32 v183, a35
    v_accvgpr_read_b32 v184, a36
    v_accvgpr_read_b32 v185, a37
    v_accvgpr_read_b32 v186, a38
    v_accvgpr_read_b32 v187, a39
    v_accvgpr_read_b32 v188, a40
    v_accvgpr_read_b32 v189, a41
    v_accvgpr_read_b32 v190, a42
    v_accvgpr_read_b32 v191, a43
    v_accvgpr_read_b32 v192, a44
    v_accvgpr_read_b32 v193, a45
    v_accvgpr_read_b32 v194, a46
    v_accvgpr_read_b32 v195, a47
    v_accvgpr_read_b32 v196, a96
    v_accvgpr_read_b32 v197, a97
    v_accvgpr_read_b32 v198, a98
    v_accvgpr_read_b32 v199, a99
    v_accvgpr_read_b32 v200, a100
    v_accvgpr_read_b32 v201, a101
    v_accvgpr_read_b32 v202, a102
    v_accvgpr_read_b32 v203, a103
    v_accvgpr_read_b32 v204, a104
    v_accvgpr_read_b32 v205, a105
    v_accvgpr_read_b32 v206, a106
    v_accvgpr_read_b32 v207, a107
    v_accvgpr_read_b32 v208, a108
    v_accvgpr_read_b32 v209, a109
    v_accvgpr_read_b32 v210, a110
    v_accvgpr_read_b32 v211, a111
K2_OWN2:
    s_nop 1
    s_cmp_lg_u32 s34, 3
    s_cbranch_scc1 K2_OWN3
    s_nop 4
    v_accvgpr_read_b32 v180, a48
    v_accvgpr_read_b32 v181, a49
    v_accvgpr_read_b32 v182, a50
    v_accvgpr_read_b32 v183, a51
    v_accvgpr_read_b32 v184, a52
    v_accvgpr_read_b32 v185, a53
    v_accvgpr_read_b32 v186, a54
    v_accvgpr_read_b32 v187, a55
    v_accvgpr_read_b32 v188, a56
    v_accvgpr_read_b32 v189, a57
    v_accvgpr_read_b32 v190, a58
    v_accvgpr_read_b32 v191, a59
    v_accvgpr_read_b32 v192, a60
    v_accvgpr_read_b32 v193, a61
    v_accvgpr_read_b32 v194, a62
    v_accvgpr_read_b32 v195, a63
    v_accvgpr_read_b32 v196, a112
    v_accvgpr_read_b32 v197, a113
    v_accvgpr_read_b32 v198, a114
    v_accvgpr_read_b32 v199, a115
    v_accvgpr_read_b32 v200, a116
    v_accvgpr_read_b32 v201, a117
    v_accvgpr_read_b32 v202, a118
    v_accvgpr_read_b32 v203, a119
    v_accvgpr_read_b32 v204, a120
    v_accvgpr_read_b32 v205, a121
    v_accvgpr_read_b32 v206, a122
    v_accvgpr_read_b32 v207, a123
    v_accvgpr_read_b32 v208, a124
    v_accvgpr_read_b32 v209, a125
    v_accvgpr_read_b32 v210, a126
    v_accvgpr_read_b32 v211, a127
K2_OWN3:
    s_nop 1
    s_add_u32 s53, s34, 1
    s_and_b32 s53, s53, 3
    s_lshl_b32 s53, s53, 15
    v_add_u32 v7, s53, v6
    ds_read_b128 v[16:19], v7 offset:0
    ds_read_b128 v[20:23], v7 offset:1024
    ds_read_b128 v[24:27], v7 offset:2048
    ds_read_b128 v[28:31], v7 offset:3072
    ds_read_b128 v[32:35], v7 offset:16384
    ds_read_b128 v[36:39], v7 offset:17408
    ds_read_b128 v[40:43], v7 offset:18432
    ds_read_b128 v[44:47], v7 offset:19456
    s_waitcnt lgkmcnt(7)
    v_add_f32 v180, v180, v16
    v_add_f32 v181, v181, v17
    v_add_f32 v182, v182, v18
    v_add_f32 v183, v183, v19
    s_waitcnt lgkmcnt(6)
    v_add_f32 v184, v184, v20
    v_add_f32 v185, v185, v21
    v_add_f32 v186, v186, v22
    v_add_f32 v187, v187, v23
    s_waitcnt lgkmcnt(5)
    v_add_f32 v188, v188, v24
    v_add_f32 v189, v189, v25
    v_add_f32 v190, v190, v26
    v_add_f32 v191, v191, v27
    s_waitcnt lgkmcnt(4)
    v_add_f32 v192, v192, v28
    v_add_f32 v193, v193, v29
    v_add_f32 v194, v194, v30
    v_add_f32 v195, v195, v31
    s_waitcnt lgkmcnt(3)
    v_add_f32 v196, v196, v32
    v_add_f32 v197, v197, v33
    v_add_f32 v198, v198, v34
    v_add_f32 v199, v199, v35
    s_waitcnt lgkmcnt(2)
    v_add_f32 v200, v200, v36
    v_add_f32 v201, v201, v37
    v_add_f32 v202, v202, v38
    v_add_f32 v203, v203, v39
    s_waitcnt lgkmcnt(1)
    v_add_f32 v204, v204, v40
    v_add_f32 v205, v205, v41
    v_add_f32 v206, v206, v42
    v_add_f32 v207, v207, v43
    s_waitcnt lgkmcnt(0)
    v_add_f32 v208, v208, v44
    v_add_f32 v209, v209, v45
    v_add_f32 v210, v210, v46
    v_add_f32 v211, v211, v47
    s_add_u32 s53, s34, 2
    s_and_b32 s53, s53, 3
    s_lshl_b32 s53, s53, 15
    v_add_u32 v7, s53, v6
    ds_read_b128 v[16:19], v7 offset:0
    ds_read_b128 v[20:23], v7 offset:1024
    ds_read_b128 v[24:27], v7 offset:2048
    ds_read_b128 v[28:31], v7 offset:3072
    ds_read_b128 v[32:35], v7 offset:16384
    ds_read_b128 v[36:39], v7 offset:17408
    ds_read_b128 v[40:43], v7 offset:18432
    ds_read_b128 v[44:47], v7 offset:19456
    s_waitcnt lgkmcnt(7)
    v_add_f32 v180, v180, v16
    v_add_f32 v181, v181, v17
    v_add_f32 v182, v182, v18
    v_add_f32 v183, v183, v19
    s_waitcnt lgkmcnt(6)
    v_add_f32 v184, v184, v20
    v_add_f32 v185, v185, v21
    v_add_f32 v186, v186, v22
    v_add_f32 v187, v187, v23
    s_waitcnt lgkmcnt(5)
    v_add_f32 v188, v188, v24
    v_add_f32 v189, v189, v25
    v_add_f32 v190, v190, v26
    v_add_f32 v191, v191, v27
    s_waitcnt lgkmcnt(4)
    v_add_f32 v192, v192, v28
    v_add_f32 v193, v193, v29
    v_add_f32 v194, v194, v30
    v_add_f32 v195, v195, v31
    s_waitcnt lgkmcnt(3)
    v_add_f32 v196, v196, v32
    v_add_f32 v197, v197, v33
    v_add_f32 v198, v198, v34
    v_add_f32 v199, v199, v35
    s_waitcnt lgkmcnt(2)
    v_add_f32 v200, v200, v36
    v_add_f32 v201, v201, v37
    v_add_f32 v202, v202, v38
    v_add_f32 v203, v203, v39
    s_waitcnt lgkmcnt(1)
    v_add_f32 v204, v204, v40
    v_add_f32 v205, v205, v41
    v_add_f32 v206, v206, v42
    v_add_f32 v207, v207, v43
    s_waitcnt lgkmcnt(0)
    v_add_f32 v208, v208, v44
    v_add_f32 v209, v209, v45
    v_add_f32 v210, v210, v46
    v_add_f32 v211, v211, v47
    s_add_u32 s53, s34, 3
    s_and_b32 s53, s53, 3
    s_lshl_b32 s53, s53, 15
    v_add_u32 v7, s53, v6
    ds_read_b128 v[16:19], v7 offset:0
    ds_read_b128 v[20:23], v7 offset:1024
    ds_read_b128 v[24:27], v7 offset:2048
    ds_read_b128 v[28:31], v7 offset:3072
    ds_read_b128 v[32:35], v7 offset:16384
    ds_read_b128 v[36:39], v7 offset:17408
    ds_read_b128 v[40:43], v7 offset:18432
    ds_read_b128 v[44:47], v7 offset:19456
    s_waitcnt lgkmcnt(7)
    v_add_f32 v180, v180, v16
    v_add_f32 v181, v181, v17
    v_add_f32 v182, v182, v18
    v_add_f32 v183, v183, v19
    s_waitcnt lgkmcnt(6)
    v_add_f32 v184, v184, v20
    v_add_f32 v185, v185, v21
    v_add_f32 v186, v186, v22
    v_add_f32 v187, v187, v23
    s_waitcnt lgkmcnt(5)
    v_add_f32 v188, v188, v24
    v_add_f32 v189, v189, v25
    v_add_f32 v190, v190, v26
    v_add_f32 v191, v191, v27
    s_waitcnt lgkmcnt(4)
    v_add_f32 v192, v192, v28
    v_add_f32 v193, v193, v29
    v_add_f32 v194, v194, v30
    v_add_f32 v195, v195, v31
    s_waitcnt lgkmcnt(3)
    v_add_f32 v196, v196, v32
    v_add_f32 v197, v197, v33
    v_add_f32 v198, v198, v34
    v_add_f32 v199, v199, v35
    s_waitcnt lgkmcnt(2)
    v_add_f32 v200, v200, v36
    v_add_f32 v201, v201, v37
    v_add_f32 v202, v202, v38
    v_add_f32 v203, v203, v39
    s_waitcnt lgkmcnt(1)
    v_add_f32 v204, v204, v40
    v_add_f32 v205, v205, v41
    v_add_f32 v206, v206, v42
    v_add_f32 v207, v207, v43
    s_waitcnt lgkmcnt(0)
    v_add_f32 v208, v208, v44
    v_add_f32 v209, v209, v45
    v_add_f32 v210, v210, v46
    v_add_f32 v211, v211, v47
    v_cvt_pk_bf16_f32 v64, v180, v181
    v_cvt_pk_bf16_f32 v65, v182, v183
    v_lshlrev_b32 v180, 16, v64
    v_and_b32 v181, 0xffff0000, v64
    v_lshlrev_b32 v182, 16, v65
    v_and_b32 v183, 0xffff0000, v65
    v_mul_f32 v68, 0xbfb8aa3b, v180
    v_mul_f32 v69, 0xbfb8aa3b, v181
    v_mul_f32 v70, 0xbfb8aa3b, v182
    v_mul_f32 v71, 0xbfb8aa3b, v183
    v_exp_f32 v68, v68
    v_exp_f32 v69, v69
    v_exp_f32 v70, v70
    v_exp_f32 v71, v71
    v_add_f32 v68, 1.0, v68
    v_add_f32 v69, 1.0, v69
    v_add_f32 v70, 1.0, v70
    v_add_f32 v71, 1.0, v71
    v_rcp_f32 v68, v68
    v_rcp_f32 v69, v69
    v_rcp_f32 v70, v70
    v_rcp_f32 v71, v71
    v_mul_f32 v68, v180, v68
    v_mul_f32 v69, v181, v69
    v_mul_f32 v70, v182, v70
    v_mul_f32 v71, v183, v71
    v_cvt_pk_bf16_f32 v64, v68, v69
    v_cvt_pk_bf16_f32 v65, v70, v71
    v_lshlrev_b32 v68, 16, v64
    v_and_b32 v69, 0xffff0000, v64
    v_lshlrev_b32 v70, 16, v65
    v_and_b32 v71, 0xffff0000, v65
    v_cvt_pk_bf16_f32 v64, v196, v197
    v_cvt_pk_bf16_f32 v65, v198, v199
    v_lshlrev_b32 v196, 16, v64
    v_and_b32 v197, 0xffff0000, v64
    v_lshlrev_b32 v198, 16, v65
    v_and_b32 v199, 0xffff0000, v65
    v_mul_f32 v68, v196, v68
    v_mul_f32 v69, v197, v69
    v_mul_f32 v70, v198, v70
    v_mul_f32 v71, v199, v71
    v_cvt_pk_bf16_f32 v64, v68, v69
    v_cvt_pk_bf16_f32 v65, v70, v71
    v_lshlrev_b32 v68, 16, v64
    v_and_b32 v69, 0xffff0000, v64
    v_lshlrev_b32 v70, 16, v65
    v_and_b32 v71, 0xffff0000, v65
    v_lshlrev_b32 v72, 16, v8
    v_and_b32 v73, 0xffff0000, v8
    v_lshlrev_b32 v74, 16, v9
    v_and_b32 v75, 0xffff0000, v9
    v_add_f32 v68, v72, v68
    v_add_f32 v69, v73, v69
    v_add_f32 v70, v74, v70
    v_add_f32 v71, v75, v71
    v_cvt_pk_bf16_f32 v76, v68, v69
    v_cvt_pk_bf16_f32 v77, v70, v71
    buffer_store_dwordx2 v[76:77], v4, s[64:67], s57 offen offset:0 sc1
    v_cvt_pk_bf16_f32 v64, v184, v185
    v_cvt_pk_bf16_f32 v65, v186, v187
    v_lshlrev_b32 v184, 16, v64
    v_and_b32 v185, 0xffff0000, v64
    v_lshlrev_b32 v186, 16, v65
    v_and_b32 v187, 0xffff0000, v65
    v_mul_f32 v68, 0xbfb8aa3b, v184
    v_mul_f32 v69, 0xbfb8aa3b, v185
    v_mul_f32 v70, 0xbfb8aa3b, v186
    v_mul_f32 v71, 0xbfb8aa3b, v187
    v_exp_f32 v68, v68
    v_exp_f32 v69, v69
    v_exp_f32 v70, v70
    v_exp_f32 v71, v71
    v_add_f32 v68, 1.0, v68
    v_add_f32 v69, 1.0, v69
    v_add_f32 v70, 1.0, v70
    v_add_f32 v71, 1.0, v71
    v_rcp_f32 v68, v68
    v_rcp_f32 v69, v69
    v_rcp_f32 v70, v70
    v_rcp_f32 v71, v71
    v_mul_f32 v68, v184, v68
    v_mul_f32 v69, v185, v69
    v_mul_f32 v70, v186, v70
    v_mul_f32 v71, v187, v71
    v_cvt_pk_bf16_f32 v64, v68, v69
    v_cvt_pk_bf16_f32 v65, v70, v71
    v_lshlrev_b32 v68, 16, v64
    v_and_b32 v69, 0xffff0000, v64
    v_lshlrev_b32 v70, 16, v65
    v_and_b32 v71, 0xffff0000, v65
    v_cvt_pk_bf16_f32 v64, v200, v201
    v_cvt_pk_bf16_f32 v65, v202, v203
    v_lshlrev_b32 v200, 16, v64
    v_and_b32 v201, 0xffff0000, v64
    v_lshlrev_b32 v202, 16, v65
    v_and_b32 v203, 0xffff0000, v65
    v_mul_f32 v68, v200, v68
    v_mul_f32 v69, v201, v69
    v_mul_f32 v70, v202, v70
    v_mul_f32 v71, v203, v71
    v_cvt_pk_bf16_f32 v64, v68, v69
    v_cvt_pk_bf16_f32 v65, v70, v71
    v_lshlrev_b32 v68, 16, v64
    v_and_b32 v69, 0xffff0000, v64
    v_lshlrev_b32 v70, 16, v65
    v_and_b32 v71, 0xffff0000, v65
    v_lshlrev_b32 v72, 16, v10
    v_and_b32 v73, 0xffff0000, v10
    v_lshlrev_b32 v74, 16, v11
    v_and_b32 v75, 0xffff0000, v11
    v_add_f32 v68, v72, v68
    v_add_f32 v69, v73, v69
    v_add_f32 v70, v74, v70
    v_add_f32 v71, v75, v71
    v_cvt_pk_bf16_f32 v78, v68, v69
    v_cvt_pk_bf16_f32 v79, v70, v71
    buffer_store_dwordx2 v[78:79], v4, s[64:67], s57 offen offset:32 sc1
    v_cvt_pk_bf16_f32 v64, v188, v189
    v_cvt_pk_bf16_f32 v65, v190, v191
    v_lshlrev_b32 v188, 16, v64
    v_and_b32 v189, 0xffff0000, v64
    v_lshlrev_b32 v190, 16, v65
    v_and_b32 v191, 0xffff0000, v65
    v_mul_f32 v68, 0xbfb8aa3b, v188
    v_mul_f32 v69, 0xbfb8aa3b, v189
    v_mul_f32 v70, 0xbfb8aa3b, v190
    v_mul_f32 v71, 0xbfb8aa3b, v191
    v_exp_f32 v68, v68
    v_exp_f32 v69, v69
    v_exp_f32 v70, v70
    v_exp_f32 v71, v71
    v_add_f32 v68, 1.0, v68
    v_add_f32 v69, 1.0, v69
    v_add_f32 v70, 1.0, v70
    v_add_f32 v71, 1.0, v71
    v_rcp_f32 v68, v68
    v_rcp_f32 v69, v69
    v_rcp_f32 v70, v70
    v_rcp_f32 v71, v71
    v_mul_f32 v68, v188, v68
    v_mul_f32 v69, v189, v69
    v_mul_f32 v70, v190, v70
    v_mul_f32 v71, v191, v71
    v_cvt_pk_bf16_f32 v64, v68, v69
    v_cvt_pk_bf16_f32 v65, v70, v71
    v_lshlrev_b32 v68, 16, v64
    v_and_b32 v69, 0xffff0000, v64
    v_lshlrev_b32 v70, 16, v65
    v_and_b32 v71, 0xffff0000, v65
    v_cvt_pk_bf16_f32 v64, v204, v205
    v_cvt_pk_bf16_f32 v65, v206, v207
    v_lshlrev_b32 v204, 16, v64
    v_and_b32 v205, 0xffff0000, v64
    v_lshlrev_b32 v206, 16, v65
    v_and_b32 v207, 0xffff0000, v65
    v_mul_f32 v68, v204, v68
    v_mul_f32 v69, v205, v69
    v_mul_f32 v70, v206, v70
    v_mul_f32 v71, v207, v71
    v_cvt_pk_bf16_f32 v64, v68, v69
    v_cvt_pk_bf16_f32 v65, v70, v71
    v_lshlrev_b32 v68, 16, v64
    v_and_b32 v69, 0xffff0000, v64
    v_lshlrev_b32 v70, 16, v65
    v_and_b32 v71, 0xffff0000, v65
    v_lshlrev_b32 v72, 16, v12
    v_and_b32 v73, 0xffff0000, v12
    v_lshlrev_b32 v74, 16, v13
    v_and_b32 v75, 0xffff0000, v13
    v_add_f32 v68, v72, v68
    v_add_f32 v69, v73, v69
    v_add_f32 v70, v74, v70
    v_add_f32 v71, v75, v71
    v_cvt_pk_bf16_f32 v76, v68, v69
    v_cvt_pk_bf16_f32 v77, v70, v71
    buffer_store_dwordx2 v[76:77], v4, s[64:67], s57 offen offset:64 sc1
    v_cvt_pk_bf16_f32 v64, v192, v193
    v_cvt_pk_bf16_f32 v65, v194, v195
    v_lshlrev_b32 v192, 16, v64
    v_and_b32 v193, 0xffff0000, v64
    v_lshlrev_b32 v194, 16, v65
    v_and_b32 v195, 0xffff0000, v65
    v_mul_f32 v68, 0xbfb8aa3b, v192
    v_mul_f32 v69, 0xbfb8aa3b, v193
    v_mul_f32 v70, 0xbfb8aa3b, v194
    v_mul_f32 v71, 0xbfb8aa3b, v195
    v_exp_f32 v68, v68
    v_exp_f32 v69, v69
    v_exp_f32 v70, v70
    v_exp_f32 v71, v71
    v_add_f32 v68, 1.0, v68
    v_add_f32 v69, 1.0, v69
    v_add_f32 v70, 1.0, v70
    v_add_f32 v71, 1.0, v71
    v_rcp_f32 v68, v68
    v_rcp_f32 v69, v69
    v_rcp_f32 v70, v70
    v_rcp_f32 v71, v71
    v_mul_f32 v68, v192, v68
    v_mul_f32 v69, v193, v69
    v_mul_f32 v70, v194, v70
    v_mul_f32 v71, v195, v71
    v_cvt_pk_bf16_f32 v64, v68, v69
    v_cvt_pk_bf16_f32 v65, v70, v71
    v_lshlrev_b32 v68, 16, v64
    v_and_b32 v69, 0xffff0000, v64
    v_lshlrev_b32 v70, 16, v65
    v_and_b32 v71, 0xffff0000, v65
    v_cvt_pk_bf16_f32 v64, v208, v209
    v_cvt_pk_bf16_f32 v65, v210, v211
    v_lshlrev_b32 v208, 16, v64
    v_and_b32 v209, 0xffff0000, v64
    v_lshlrev_b32 v210, 16, v65
    v_and_b32 v211, 0xffff0000, v65
    v_mul_f32 v68, v208, v68
    v_mul_f32 v69, v209, v69
    v_mul_f32 v70, v210, v70
    v_mul_f32 v71, v211, v71
    v_cvt_pk_bf16_f32 v64, v68, v69
    v_cvt_pk_bf16_f32 v65, v70, v71
    v_lshlrev_b32 v68, 16, v64
    v_and_b32 v69, 0xffff0000, v64
    v_lshlrev_b32 v70, 16, v65
    v_and_b32 v71, 0xffff0000, v65
    v_lshlrev_b32 v72, 16, v14
    v_and_b32 v73, 0xffff0000, v14
    v_lshlrev_b32 v74, 16, v15
    v_and_b32 v75, 0xffff0000, v15
    v_add_f32 v68, v72, v68
    v_add_f32 v69, v73, v69
    v_add_f32 v70, v74, v70
    v_add_f32 v71, v75, v71
    v_cvt_pk_bf16_f32 v78, v68, v69
    v_cvt_pk_bf16_f32 v79, v70, v71
    buffer_store_dwordx2 v[78:79], v4, s[64:67], s57 offen offset:96 sc1
K2_END:
    s_endpgm
.section .rodata,"a"
.p2align 6
.amdhsa_kernel recurrent_scan__linear_attn_block__geglu_ffn__prompt_kernel
  .amdhsa_next_free_vgpr 64
  .amdhsa_next_free_sgpr 96
  .amdhsa_accum_offset 64
  .amdhsa_group_segment_fixed_size 0
  .amdhsa_kernarg_size 80
  .amdhsa_user_sgpr_count 2
  .amdhsa_user_sgpr_kernarg_segment_ptr 1
  .amdhsa_system_sgpr_workgroup_id_x 1
.end_amdhsa_kernel

.p2align 6
.amdhsa_kernel k1_gemm_kernel
  .amdhsa_next_free_vgpr 208
  .amdhsa_next_free_sgpr 80
  .amdhsa_accum_offset 208
  .amdhsa_group_segment_fixed_size 0
  .amdhsa_kernarg_size 80
  .amdhsa_user_sgpr_count 2
  .amdhsa_user_sgpr_kernarg_segment_ptr 1
  .amdhsa_system_sgpr_workgroup_id_x 1
.end_amdhsa_kernel

.p2align 6
.amdhsa_kernel k2_gemm_kernel
  .amdhsa_next_free_vgpr 500
  .amdhsa_next_free_sgpr 80
  .amdhsa_accum_offset 244
  .amdhsa_group_segment_fixed_size 0
  .amdhsa_kernarg_size 80
  .amdhsa_user_sgpr_count 2
  .amdhsa_user_sgpr_kernarg_segment_ptr 1
  .amdhsa_system_sgpr_workgroup_id_x 1
.end_amdhsa_kernel
```
